```python
import torch

def _softmax(x, axis=-1):
    return torch.softmax(x, dim=axis)
def _gelu(x):
    return torch.nn.functional.gelu(x, approximate="tanh")
def _silu(x):
    return torch.nn.functional.silu(x)
def _sigmoid(x):
    return torch.sigmoid(x)
def _layernorm(x, axis=-1, eps=1e-5):
    m = x.mean(dim=axis, keepdim=True)
    v = x.var(dim=axis, keepdim=True, unbiased=False)
    return (x - m) / torch.sqrt(v + eps)
def _scatter_add(tgt, idx, src, axis=0):
    return tgt.clone().index_add_(axis, idx, src)
def _segment_sum(src, seg, n):
    out = torch.zeros((n,) + src.shape[1:], dtype=src.dtype)
    return out.index_add_(0, seg, src)
def _pad(x, pw):
    flat = tuple(v for pair in reversed(pw) for v in pair)
    return torch.nn.functional.pad(x, flat)

kernel_name = 'interleave_layers__sliding_block__mixer_channel_mlp__prompt'

def setup_inputs():

    _w = (lambda a: (lambda t: t.to(torch.bfloat16) if t.is_floating_point() else t)(torch.as_tensor(a)))
    def _A_setup():
        B, S, D = 1, 2048, 576
        return {
            "x": _w((lambda *s: torch.randn(*s, dtype=torch.bfloat16) * 0.05)(B, S, D)),
            "wqkv": _w((lambda *s: torch.randn(*s, dtype=torch.bfloat16) * 0.05)(D, 3 * D)),
            "wo": _w((lambda *s: torch.randn(*s, dtype=torch.bfloat16) * 0.05)(D, D)),
        }
    _A_in = _A_setup()

    def _B_setup():
        B, S, D, F = 1, 2048, 576, 4608
        return {
            "x": _w((lambda *s: torch.randn(*s, dtype=torch.bfloat16) * 0.05)(B, S, D)),
            "w1": _w((lambda *s: torch.randn(*s, dtype=torch.bfloat16) * 3.2)(D, F) * (D ** -0.5)),
            "b1": _w((lambda *s: torch.randn(*s, dtype=torch.bfloat16) * 3.2)(F)),
            "w2": _w((lambda *s: torch.randn(*s, dtype=torch.bfloat16) * 0.4)(F, D) * (F ** -0.5)),
            "b2": _w((lambda *s: torch.randn(*s, dtype=torch.bfloat16) * 0.4)(D)),
        }
    _B_in = _B_setup()

    return {
        "A_x": _A_in["x"],
        "A_wqkv": _A_in["wqkv"],
        "A_wo": _A_in["wo"],
        "B_x": _B_in["x"],
        "B_w1": _B_in["w1"],
        "B_b1": _B_in["b1"],
        "B_w2": _B_in["w2"],
        "B_b2": _B_in["b2"],
    }

def reference(A_x, A_wqkv, A_wo, B_x, B_w1, B_b1, B_w2, B_b2):
    def _A_ref(x, wqkv, wo):
        B, S, D = x.shape
        H = 32; Dh = D // H; W = 256
        qkv = (lambda x, *d: x.permute(*d))((x @ wqkv).reshape(B, S, 3, H, Dh), 2, 0, 3, 1, 4)
        q, k, v = qkv[0], qkv[1], qkv[2]
        scores = torch.einsum("bhqd,bhkd->bhqk", q, k) * (Dh ** -0.5)
        idx = torch.arange(S)
        mask = (idx[:, None] - idx[None, :] >= 0) & (idx[:, None] - idx[None, :] < W)
        scores = torch.where(mask[None, None], scores, -1e9)
        p = _softmax(scores, axis=-1)
        o = torch.einsum("bhqk,bhkd->bhqd", p, v)
        return (lambda x, *d: x.permute(*d))(o, 0, 2, 1, 3).reshape(B, S, D) @ wo

    def _B_ref(x, w1, b1, w2, b2):
        y = _layernorm(x, axis=-1)
        h = _gelu(torch.einsum("bsd,df->bsf", y, w1) + b1)
        return torch.einsum("bsf,fd->bsd", h, w2) + b2

    x = A_x
    x = x + _A_ref(_layernorm(x, axis=-1), A_wqkv, A_wo)
    x = x + _B_ref(_layernorm(x, axis=-1), B_w1, B_b1, B_w2, B_b2)
    x = x + _A_ref(_layernorm(x, axis=-1), A_wqkv, A_wo)
    x = x + _B_ref(_layernorm(x, axis=-1), B_w1, B_b1, B_w2, B_b2)
    return x
```

```asm
; @launch kernel=main_kernel grid=(256,1,1) block=(768,1,1) lds=158720
.amdgcn_target "amdgcn-amd-amdhsa--gfx950"
.text
.globl main_kernel
.p2align 8
.type main_kernel,@function
main_kernel:
    s_cmp_ge_u32 s2, 256
    s_cbranch_scc1 M_END
    s_load_dwordx2 s[26:27], s[0:1], 0
    s_load_dwordx2 s[28:29], s[0:1], 40
    s_load_dwordx4 s[32:35], s[0:1], 56
    s_load_dwordx2 s[30:31], s[0:1], 80
    v_lshrrev_b32 v2, 6, v0
    v_and_b32 v0, 63, v0
    v_readfirstlane_b32 s22, v2
    v_lshlrev_b32 v1, 4, v0
    s_and_b32 s36, s2, 1
    s_lshl_b32 s36, s36, 2
    s_bfe_u32 s37, s2, 0x20003
    s_add_u32 s21, s36, s37
    s_bfe_u32 s36, s2, 0x20001
    s_xor_b32 s36, s36, 3
    s_lshl_b32 s36, s36, 3
    s_lshr_b32 s37, s2, 5
    s_add_u32 s20, s36, s37
    s_mov_b32 s23, 0
    s_mov_b32 s24, 1
    s_mov_b32 s25, 0
    s_mul_i32 s36, s22, 36864
    s_mul_i32 s37, s22, 18432
    s_add_u32 s37, s37, 73728
    s_cmp_lt_u32 s22, 4
    s_cselect_b32 s36, s36, s37
    s_cmp_ge_u32 s22, 8
    s_cselect_b32 s36, 221184, s36
    s_cmp_ge_u32 s22, 10
    s_cselect_b32 s36, 239616, s36
    s_mul_i32 s37, s21, 258048
    s_add_u32 s36, s36, s37
    s_add_u32 s40, s36, 1048576
    s_sub_u32 s36, s22, 8
    s_min_u32 s36, s36, 4
    s_mul_i32 s36, s36, 18432
    s_mul_i32 s37, s21, 92160
    s_add_u32 s36, s36, s37
    s_add_u32 s41, s36, 3112960
    s_mul_i32 s36, s22, 110592
    s_mul_i32 s37, s21, 1327104
    s_add_u32 s36, s36, s37
    s_add_u32 s42, s36, 3850240
    s_and_b32 s36, s22, 3
    s_min_u32 s36, s36, 2
    s_lshr_b32 s37, s22, 2
    s_mul_i32 s37, s37, 3
    s_add_u32 s63, s36, s37
    s_lshl_b32 s36, s63, 4
    s_mul_i32 s37, s21, 144
    s_add_u32 s43, s36, s37
    s_waitcnt lgkmcnt(0)
    s_load_dwordx4 s[44:47], s[32:33], s43
    s_mov_b32 s4, s30
    s_mov_b32 s5, s31
    s_mov_b32 s6, 73449472
    s_mov_b32 s7, 0x20000
    s_mov_b32 s8, s26
    s_mov_b32 s9, s27
    s_mov_b32 s10, 2359296
    s_mov_b32 s11, 0x20000
    s_mov_b32 s12, s34
    s_mov_b32 s13, s35
    s_mov_b32 s14, 2359296
    s_mov_b32 s15, 0x20000
    s_mov_b32 s16, s28
    s_mov_b32 s17, s29
    s_mov_b32 s18, 9216
    s_mov_b32 s19, 0x20000
    s_mov_b32 s100, s20
    s_load_dwordx4 s[28:31], s[0:1], 8
    s_load_dwordx2 s[56:57], s[0:1], 72
    s_mov_b32 s58, 256
    s_mov_b32 s59, 0x20000
    s_cmp_lt_u32 s22, 8
    s_cbranch_scc1 E_NZ
    s_lshl_b32 s27, s100, 3
    s_add_u32 s27, s27, s21
    s_cmp_lg_u32 s27, 255
    s_cbranch_scc1 E_NZ
    v_mov_b32 v8, 0
    v_mov_b32 v9, 0
    v_mov_b32 v10, 0
    v_mov_b32 v11, 0
    s_sub_u32 s27, s22, 8
    s_mul_i32 s27, s27, 6144
    s_add_u32 s36, s27, 3072
    buffer_store_dwordx4 v[8:11], v1, s[4:7], s27 offen offset:0 sc1
    buffer_store_dwordx4 v[8:11], v1, s[4:7], s27 offen offset:1024 sc1
    buffer_store_dwordx4 v[8:11], v1, s[4:7], s27 offen offset:2048 sc1
    buffer_store_dwordx4 v[8:11], v1, s[4:7], s36 offen offset:0 sc1
    buffer_store_dwordx4 v[8:11], v1, s[4:7], s36 offen offset:1024 sc1
    buffer_store_dwordx4 v[8:11], v1, s[4:7], s36 offen offset:2048 sc1
E_NZ:
    s_cmp_ge_u32 s100, 18
    s_cbranch_scc1 E_NL
    s_lshl_b32 s27, s22, 6
    v_add_u32 v2, s27, v0
    s_movk_i32 s36, 3456
    s_movk_i32 s37, 1152
    s_mul_i32 s38, s21, 144
    s_waitcnt lgkmcnt(0)
    s_mov_b32 s32, s28
    s_mov_b32 s33, s29
    s_mov_b32 s34, 1990656
    s_mov_b32 s35, 0x20000
    s_mul_i32 s39, s100, 110592
    s_add_u32 s39, s39, s38
    v_mul_u32_u24 v3, 2428, v2
    v_lshrrev_b32 v3, 16, v3
    v_mul_u32_u24 v4, 27, v3
    v_sub_u32 v4, v2, v4
    v_mul_u32_u24 v5, 57, v4
    v_lshrrev_b32 v5, 9, v5
    v_mul_u32_u24 v6, 9, v5
    v_sub_u32 v6, v4, v6
    v_lshlrev_b32 v6, 4, v6
    v_mad_u32_u24 v6, v5, s37, v6
    v_mad_u32_u24 v6, v3, s36, v6
    v_mul_u32_u24 v3, 592, v3
    v_lshl_add_u32 v16, v4, 4, v3
    buffer_load_dwordx4 v[8:11], v6, s[32:35], s39 offen
    s_cmp_ge_u32 s22, 2
    s_cbranch_scc1 E_WO
    v_add_u32 v2, 768, v2
    v_min_u32 v2, 863, v2
    v_mul_u32_u24 v3, 2428, v2
    v_lshrrev_b32 v3, 16, v3
    v_mul_u32_u24 v4, 27, v3
    v_sub_u32 v4, v2, v4
    v_mul_u32_u24 v5, 57, v4
    v_lshrrev_b32 v5, 9, v5
    v_mul_u32_u24 v6, 9, v5
    v_sub_u32 v6, v4, v6
    v_lshlrev_b32 v6, 4, v6
    v_mad_u32_u24 v6, v5, s37, v6
    v_mad_u32_u24 v6, v3, s36, v6
    v_mul_u32_u24 v3, 592, v3
    v_lshl_add_u32 v17, v4, 4, v3
    buffer_load_dwordx4 v[12:15], v6, s[32:35], s39 offen
    s_branch E_NL
E_WO:
    v_subrev_u32 v2, 128, v2
    v_min_u32 v2, 287, v2
    s_mov_b32 s32, s30
    s_mov_b32 s33, s31
    s_mov_b32 s34, 663552
    s_mul_i32 s39, s100, 36864
    s_add_u32 s39, s39, s38
    v_mul_u32_u24 v3, 7282, v2
    v_lshrrev_b32 v3, 16, v3
    v_mul_u32_u24 v4, 9, v3
    v_sub_u32 v4, v2, v4
    v_lshlrev_b32 v4, 4, v4
    v_mad_u32_u24 v6, v3, s37, v4
    v_mul_u32_u24 v3, 592, v3
    v_add_u32 v17, v3, v4
    v_add_u32 v17, 432, v17
    buffer_load_dwordx4 v[12:15], v6, s[32:35], s39 offen
E_NL:
    s_lshl_b32 s36, s20, 6
    v_add_u32 v2, s36, v0
    v_mul_u32_u24 v2, 1152, v2
    s_and_b32 s37, s22, 3
    s_lshl_b32 s37, s37, 4
    s_add_u32 s36, s36, s37
    v_and_b32 v3, 15, v0
    v_add_u32 v3, s36, v3
    v_mul_u32_u24 v3, 1152, v3
    v_lshrrev_b32 v4, 4, v0
    v_lshl_add_u32 v3, v4, 4, v3
    s_lshr_b32 s36, s22, 2
    s_mul_i32 s36, s36, 384
    buffer_load_dwordx4 v[128:131], v3, s[8:11], s36 offen offset:0
    buffer_load_dwordx4 v[132:135], v3, s[8:11], s36 offen offset:64
    buffer_load_dwordx4 v[136:139], v3, s[8:11], s36 offen offset:128
    buffer_load_dwordx4 v[140:143], v3, s[8:11], s36 offen offset:192
    buffer_load_dwordx4 v[144:147], v3, s[8:11], s36 offen offset:256
    buffer_load_dwordx4 v[148:151], v3, s[8:11], s36 offen offset:320
    buffer_load_dwordx4 v[160:163], v2, s[8:11], s43 offen
    v_and_b32 v2, 31, v0
    v_lshrrev_b32 v3, 5, v0
    v_lshlrev_b32 v3, 2, v3
    v_sub_u32 v2, v2, v3
    v_cmp_le_i32 s[64:65], 0, v2
    v_cmp_le_i32 s[66:67], 1, v2
    v_cmp_le_i32 s[68:69], 2, v2
    v_cmp_le_i32 s[70:71], 3, v2
    v_cmp_le_i32 s[72:73], 16, v2
    v_cmp_le_i32 s[74:75], 17, v2
    v_cmp_le_i32 s[76:77], 18, v2
    v_cmp_le_i32 s[78:79], 19, v2
    v_cmp_le_i32 s[80:81], 8, v2
    v_cmp_le_i32 s[82:83], 9, v2
    v_cmp_le_i32 s[84:85], 10, v2
    v_cmp_le_i32 s[86:87], 11, v2
    v_cmp_le_i32 s[88:89], 24, v2
    v_cmp_le_i32 s[90:91], 25, v2
    v_cmp_le_i32 s[92:93], 26, v2
    v_cmp_le_i32 s[94:95], 27, v2
    s_mov_b32 s60, 0x3eae1a93
    s_waitcnt lgkmcnt(0)
    s_lshl_b32 s48, s44, 16
    s_and_b32 s49, s44, 0xffff0000
    s_lshl_b32 s50, s45, 16
    s_and_b32 s51, s45, 0xffff0000
    s_lshl_b32 s52, s46, 16
    s_and_b32 s53, s46, 0xffff0000
    s_lshl_b32 s54, s47, 16
    s_and_b32 s55, s47, 0xffff0000
    v_mov_b32 v4, 0
    v_lshlrev_b32 v3, 5, v0
    v_add_u32 v3, 131072, v3
    s_mov_b64 exec, 0xff
    ds_write_b32 v3, v4 offset:25624
    s_mov_b64 exec, -1
    s_lshl_b32 s36, s63, 10
    s_add_u32 s36, s36, 147456
    v_add_u32 v2, s36, v1
    v_mov_b32 v164, v2
    s_cmp_ge_u32 s100, 18
    s_cbranch_scc1 E_B1
    v_add_u32 v16, 99328, v16
    v_add_u32 v17, 99328, v17
    s_waitcnt vmcnt(7)
    ds_write_b128 v16, v[8:11]
    ds_write_b128 v17, v[12:15]
    s_waitcnt lgkmcnt(0)
E_B1:
    s_lshl_b32 s27, s100, 3
    s_add_u32 s27, s27, s21
    s_cmp_lg_u32 s27, 255
    s_cbranch_scc1 E_B2
    s_waitcnt vmcnt(7)
    s_barrier
    s_cmp_lg_u32 s22, 11
    s_cbranch_scc1 E_NS
    v_mov_b32 v3, 1
    v_mov_b32 v4, 0
    s_mov_b64 exec, 1
    buffer_store_dword v3, v4, s[56:59], 0 offen sc1
    s_mov_b64 exec, -1
    s_branch E_NS
E_B2:
    s_barrier
    s_cmp_ge_u32 s100, 18
    s_cbranch_scc1 E_NS
    s_cmp_eq_u32 s22, 11
    s_cbranch_scc1 E_NS
    v_and_b32 v2, 15, v0
    v_lshrrev_b32 v3, 4, v0
    v_mul_u32_u24 v3, 4736, v3
    v_add_u32 v3, 99328, v3
    v_lshl_add_u32 v4, v2, 1, v3
    s_mul_i32 s27, s22, 36
    s_lshl_b32 s28, s22, 5
    s_add_u32 s29, s28, 304
    s_add_u32 s28, s28, 160
    s_add_u32 s30, s27, 144
    s_cmp_lt_u32 s22, 4
    s_cselect_b32 s28, s30, s28
    s_cselect_b32 s29, s27, s29
    s_cmp_eq_u32 s22, 10
    s_cselect_b32 s28, 560, s28
    v_add_u32 v16, s28, v4
    v_add_u32 v17, s29, v4
    v_lshrrev_b32 v5, 2, v2
    v_mul_u32_u24 v5, 36, v5
    v_and_b32 v6, 1, v2
    v_lshl_add_u32 v5, v6, 1, v5
    v_add_u32 v5, v3, v5
    v_and_b32 v6, 2, v2
    v_cmp_eq_u32 vcc, 0, v6
    v_add_u32 v6, 32, v5
    v_add_u32 v5, 176, v5
    v_cndmask_b32 v5, v6, v5, vcc
    s_cmp_eq_u32 s22, 9
    s_cselect_b64 vcc, -1, 0
    v_cndmask_b32 v16, v16, v5, vcc
    ds_read_u16 v24, v16 offset:0
    ds_read_u16 v25, v16 offset:592
    ds_read_u16 v26, v16 offset:1184
    ds_read_u16 v27, v16 offset:1776
    ds_read_u16 v28, v16 offset:2368
    ds_read_u16 v29, v16 offset:2960
    ds_read_u16 v30, v16 offset:3552
    ds_read_u16 v31, v16 offset:4144
    s_cmp_ge_u32 s22, 8
    s_cbranch_scc1 E_S1
    ds_read_u16 v32, v17 offset:0
    ds_read_u16 v33, v17 offset:592
    ds_read_u16 v34, v17 offset:1184
    ds_read_u16 v35, v17 offset:1776
    ds_read_u16 v36, v17 offset:2368
    ds_read_u16 v37, v17 offset:2960
    ds_read_u16 v38, v17 offset:3552
    ds_read_u16 v39, v17 offset:4144
E_S1:
    s_mul_i32 s27, s21, 258048
    s_add_u32 s27, s27, 1048576
    s_mul_i32 s28, s21, 92160
    s_add_u32 s28, s28, 3112960
    s_lshl_b32 s29, s100, 10
    s_add_u32 s27, s27, s29
    s_add_u32 s28, s28, s29
    s_mul_i32 s30, s22, 18432
    s_add_u32 s31, s27, s30
    s_add_u32 s36, s31, 73728
    s_add_u32 s37, s28, s30
    s_sub_u32 s37, s37, 73728
    s_add_u32 s31, s31, s30
    s_add_u32 s38, s31, 18432
    s_cmp_lt_u32 s22, 4
    s_cselect_b32 s36, s31, s36
    s_cselect_b32 s37, s38, s37
    s_add_u32 s28, s28, 73728
    s_cmp_eq_u32 s22, 10
    s_cselect_b32 s36, s28, s36
    s_and_b32 s27, s22, 13
    s_cmp_eq_u32 s27, 8
    s_cselect_b32 s27, 8, 16
    v_cmp_gt_u32 vcc, s27, v2
    s_waitcnt lgkmcnt(0)
    v_lshl_or_b32 v8, v25, 16, v24
    v_cndmask_b32 v8, 0, v8, vcc
    v_lshl_or_b32 v9, v27, 16, v26
    v_cndmask_b32 v9, 0, v9, vcc
    v_lshl_or_b32 v10, v29, 16, v28
    v_cndmask_b32 v10, 0, v10, vcc
    v_lshl_or_b32 v11, v31, 16, v30
    v_cndmask_b32 v11, 0, v11, vcc
    buffer_store_dwordx4 v[8:11], v1, s[4:7], s36 offen sc1
    s_cmp_ge_u32 s22, 8
    s_cbranch_scc1 E_NS
    v_lshl_or_b32 v12, v33, 16, v32
    v_lshl_or_b32 v13, v35, 16, v34
    v_lshl_or_b32 v14, v37, 16, v36
    v_lshl_or_b32 v15, v39, 16, v38
    buffer_store_dwordx4 v[12:15], v1, s[4:7], s37 offen sc1
E_NS:
    v_mov_b32 v156, 0x3f803f80
    v_mov_b32 v157, 0x3f803f80
    v_mov_b32 v158, 0x3f803f80
    v_mov_b32 v159, 0x3f803f80
    s_mov_b32 s27, 0xffff0000
    v_and_b32 v2, 15, v0
    s_and_b32 s28, s22, 3
    s_lshl_b32 s28, s28, 9
    s_add_u32 s28, s28, 156672
    v_lshl_add_u32 v2, v2, 5, s28
    s_lshr_b32 s28, s22, 2
    s_lshl_b32 s28, s28, 3
    v_add_u32 v3, s28, v2
    s_waitcnt vmcnt(6)
    v_mfma_f32_16x16x32_bf16 v[152:155], v[128:131], v[128:131], 0
    v_mfma_f32_16x16x32_bf16 v[4:7], v[156:159], v[128:131], 0
    v_lshlrev_b32 v80, 16, v128
    v_and_b32 v81, s27, v128
    v_lshlrev_b32 v82, 16, v129
    v_and_b32 v83, s27, v129
    v_lshlrev_b32 v84, 16, v130
    v_and_b32 v85, s27, v130
    v_lshlrev_b32 v86, 16, v131
    v_and_b32 v87, s27, v131
    s_waitcnt vmcnt(5)
    v_mfma_f32_16x16x32_bf16 v[152:155], v[132:135], v[132:135], v[152:155]
    v_mfma_f32_16x16x32_bf16 v[4:7], v[156:159], v[132:135], v[4:7]
    v_lshlrev_b32 v88, 16, v132
    v_and_b32 v89, s27, v132
    v_lshlrev_b32 v90, 16, v133
    v_and_b32 v91, s27, v133
    v_lshlrev_b32 v92, 16, v134
    v_and_b32 v93, s27, v134
    v_lshlrev_b32 v94, 16, v135
    v_and_b32 v95, s27, v135
    s_waitcnt vmcnt(4)
    v_mfma_f32_16x16x32_bf16 v[152:155], v[136:139], v[136:139], v[152:155]
    v_mfma_f32_16x16x32_bf16 v[4:7], v[156:159], v[136:139], v[4:7]
    s_waitcnt vmcnt(3)
    v_mfma_f32_16x16x32_bf16 v[152:155], v[140:143], v[140:143], v[152:155]
    v_mfma_f32_16x16x32_bf16 v[4:7], v[156:159], v[140:143], v[4:7]
    s_waitcnt vmcnt(2)
    v_mfma_f32_16x16x32_bf16 v[152:155], v[144:147], v[144:147], v[152:155]
    v_mfma_f32_16x16x32_bf16 v[4:7], v[156:159], v[144:147], v[4:7]
    s_waitcnt vmcnt(1)
    v_mfma_f32_16x16x32_bf16 v[152:155], v[148:151], v[148:151], v[152:155]
    v_mfma_f32_16x16x32_bf16 v[4:7], v[156:159], v[148:151], v[4:7]
    s_mov_b32 vcc_lo, 0xaaaaaaaa
    s_mov_b32 vcc_hi, 0xaaaaaaaa
    s_nop 4
    v_cndmask_b32 v152, v152, v153, vcc
    v_cndmask_b32 v154, v154, v155, vcc
    s_mov_b32 vcc_lo, 0xcccccccc
    s_mov_b32 vcc_hi, 0xcccccccc
    v_cndmask_b32 v5, v152, v154, vcc
    s_mov_b32 exec_lo, 0x00f0000f
    s_mov_b32 exec_hi, 0xf0000f00
    ds_write_b64 v3, v[4:5]
    s_mov_b64 exec, -1
    v_lshlrev_b32 v96, 16, v136
    v_and_b32 v97, s27, v136
    v_lshlrev_b32 v98, 16, v137
    v_and_b32 v99, s27, v137
    v_lshlrev_b32 v100, 16, v138
    v_and_b32 v101, s27, v138
    v_lshlrev_b32 v102, 16, v139
    v_and_b32 v103, s27, v139
    v_lshlrev_b32 v104, 16, v140
    v_and_b32 v105, s27, v140
    v_lshlrev_b32 v106, 16, v141
    v_and_b32 v107, s27, v141
    v_lshlrev_b32 v108, 16, v142
    v_and_b32 v109, s27, v142
    v_lshlrev_b32 v110, 16, v143
    v_and_b32 v111, s27, v143
    v_lshlrev_b32 v112, 16, v144
    v_and_b32 v113, s27, v144
    v_lshlrev_b32 v114, 16, v145
    v_and_b32 v115, s27, v145
    v_lshlrev_b32 v116, 16, v146
    v_and_b32 v117, s27, v146
    v_lshlrev_b32 v118, 16, v147
    v_and_b32 v119, s27, v147
    v_lshlrev_b32 v120, 16, v148
    v_and_b32 v121, s27, v148
    v_lshlrev_b32 v122, 16, v149
    v_and_b32 v123, s27, v149
    v_lshlrev_b32 v124, 16, v150
    v_and_b32 v125, s27, v150
    v_lshlrev_b32 v126, 16, v151
    v_and_b32 v127, s27, v151
    s_waitcnt vmcnt(0)
    ds_write_b128 v164, v[160:163]
    s_cmp_lg_u32 s22, 0
    s_cbranch_scc1 E_N0
    v_mov_b32 v4, 0
    s_mov_b64 exec, 1
    s_cmp_lg_u32 s25, 0
    s_cbranch_scc1 Lsd2
    s_mov_b32 s29, 400000
Lsl1:
    buffer_load_dword v3, v4, s[56:59], 0 offen sc1
    s_waitcnt vmcnt(0)
    v_cmp_gt_u32 vcc, 1, v3
    s_nop 1
    s_cbranch_vccz Lsd2
    s_sub_u32 s29, s29, 1
    s_cbranch_scc0 Lsl1
    s_mov_b32 s25, 1
Lsd2:
    s_mov_b64 exec, -1
E_N0:
    s_waitcnt lgkmcnt(0)
    s_barrier
    ds_read_b128 v[152:155], v2
    ds_read_b64 v[156:157], v2 offset:16
    s_cmp_lg_u32 s22, 0
    s_cbranch_scc1 E_NR
    s_lshl_b32 s27, s20, 8
    s_lshl_b32 s28, s21, 2
    s_add_u32 s27, s27, s28
    v_mov_b32 v3, 1
    v_mov_b32 v4, 0
    s_mov_b64 exec, 1
    buffer_store_dword v3, v4, s[4:7], s27 offen sc1
    s_mov_b64 exec, -1
E_NR:
    s_lshr_b32 s27, s22, 2
    s_mul_i32 s27, s27, 24576
    s_and_b32 s28, s22, 3
    s_lshl_b32 s28, s28, 10
    s_add_u32 s27, s27, s28
    v_add_u32 v4, s27, v1
    s_mov_b32 s27, 0x3ae38e39
    s_mov_b32 s28, 0x3727c5ac
    s_waitcnt lgkmcnt(0)
    v_add_f32 v152, v152, v154
    v_add_f32 v153, v153, v155
    v_add_f32 v152, v152, v156
    v_add_f32 v153, v153, v157
    v_mul_f32 v152, s27, v152
    v_mul_f32 v153, s27, v153
    v_fma_f32 v153, -v152, v152, v153
    v_max_f32 v153, 0, v153
    v_add_f32 v154, s28, v153
    v_rsq_f32 v154, v154
    s_nop 0
    v_mul_f32 v152, v152, v154
    v_pk_fma_f32 v[80:81], v[80:81], v[154:155], v[152:153] op_sel_hi:[1,0,0] neg_lo:[0,0,1] neg_hi:[0,0,1]
    v_pk_fma_f32 v[82:83], v[82:83], v[154:155], v[152:153] op_sel_hi:[1,0,0] neg_lo:[0,0,1] neg_hi:[0,0,1]
    v_pk_fma_f32 v[84:85], v[84:85], v[154:155], v[152:153] op_sel_hi:[1,0,0] neg_lo:[0,0,1] neg_hi:[0,0,1]
    v_pk_fma_f32 v[86:87], v[86:87], v[154:155], v[152:153] op_sel_hi:[1,0,0] neg_lo:[0,0,1] neg_hi:[0,0,1]
    v_cvt_pk_bf16_f32 v128, v80, v81
    v_cvt_pk_bf16_f32 v129, v82, v83
    v_cvt_pk_bf16_f32 v130, v84, v85
    v_cvt_pk_bf16_f32 v131, v86, v87
    ds_write_b128 v4, v[128:131] offset:0
    v_pk_fma_f32 v[88:89], v[88:89], v[154:155], v[152:153] op_sel_hi:[1,0,0] neg_lo:[0,0,1] neg_hi:[0,0,1]
    v_pk_fma_f32 v[90:91], v[90:91], v[154:155], v[152:153] op_sel_hi:[1,0,0] neg_lo:[0,0,1] neg_hi:[0,0,1]
    v_pk_fma_f32 v[92:93], v[92:93], v[154:155], v[152:153] op_sel_hi:[1,0,0] neg_lo:[0,0,1] neg_hi:[0,0,1]
    v_pk_fma_f32 v[94:95], v[94:95], v[154:155], v[152:153] op_sel_hi:[1,0,0] neg_lo:[0,0,1] neg_hi:[0,0,1]
    v_cvt_pk_bf16_f32 v132, v88, v89
    v_cvt_pk_bf16_f32 v133, v90, v91
    v_cvt_pk_bf16_f32 v134, v92, v93
    v_cvt_pk_bf16_f32 v135, v94, v95
    ds_write_b128 v4, v[132:135] offset:4096
    v_pk_fma_f32 v[96:97], v[96:97], v[154:155], v[152:153] op_sel_hi:[1,0,0] neg_lo:[0,0,1] neg_hi:[0,0,1]
    v_pk_fma_f32 v[98:99], v[98:99], v[154:155], v[152:153] op_sel_hi:[1,0,0] neg_lo:[0,0,1] neg_hi:[0,0,1]
    v_pk_fma_f32 v[100:101], v[100:101], v[154:155], v[152:153] op_sel_hi:[1,0,0] neg_lo:[0,0,1] neg_hi:[0,0,1]
    v_pk_fma_f32 v[102:103], v[102:103], v[154:155], v[152:153] op_sel_hi:[1,0,0] neg_lo:[0,0,1] neg_hi:[0,0,1]
    v_cvt_pk_bf16_f32 v136, v96, v97
    v_cvt_pk_bf16_f32 v137, v98, v99
    v_cvt_pk_bf16_f32 v138, v100, v101
    v_cvt_pk_bf16_f32 v139, v102, v103
    ds_write_b128 v4, v[136:139] offset:8192
    v_pk_fma_f32 v[104:105], v[104:105], v[154:155], v[152:153] op_sel_hi:[1,0,0] neg_lo:[0,0,1] neg_hi:[0,0,1]
    v_pk_fma_f32 v[106:107], v[106:107], v[154:155], v[152:153] op_sel_hi:[1,0,0] neg_lo:[0,0,1] neg_hi:[0,0,1]
    v_pk_fma_f32 v[108:109], v[108:109], v[154:155], v[152:153] op_sel_hi:[1,0,0] neg_lo:[0,0,1] neg_hi:[0,0,1]
    v_pk_fma_f32 v[110:111], v[110:111], v[154:155], v[152:153] op_sel_hi:[1,0,0] neg_lo:[0,0,1] neg_hi:[0,0,1]
    v_cvt_pk_bf16_f32 v140, v104, v105
    v_cvt_pk_bf16_f32 v141, v106, v107
    v_cvt_pk_bf16_f32 v142, v108, v109
    v_cvt_pk_bf16_f32 v143, v110, v111
    ds_write_b128 v4, v[140:143] offset:12288
    v_pk_fma_f32 v[112:113], v[112:113], v[154:155], v[152:153] op_sel_hi:[1,0,0] neg_lo:[0,0,1] neg_hi:[0,0,1]
    v_pk_fma_f32 v[114:115], v[114:115], v[154:155], v[152:153] op_sel_hi:[1,0,0] neg_lo:[0,0,1] neg_hi:[0,0,1]
    v_pk_fma_f32 v[116:117], v[116:117], v[154:155], v[152:153] op_sel_hi:[1,0,0] neg_lo:[0,0,1] neg_hi:[0,0,1]
    v_pk_fma_f32 v[118:119], v[118:119], v[154:155], v[152:153] op_sel_hi:[1,0,0] neg_lo:[0,0,1] neg_hi:[0,0,1]
    v_cvt_pk_bf16_f32 v144, v112, v113
    v_cvt_pk_bf16_f32 v145, v114, v115
    v_cvt_pk_bf16_f32 v146, v116, v117
    v_cvt_pk_bf16_f32 v147, v118, v119
    ds_write_b128 v4, v[144:147] offset:16384
    v_pk_fma_f32 v[120:121], v[120:121], v[154:155], v[152:153] op_sel_hi:[1,0,0] neg_lo:[0,0,1] neg_hi:[0,0,1]
    v_pk_fma_f32 v[122:123], v[122:123], v[154:155], v[152:153] op_sel_hi:[1,0,0] neg_lo:[0,0,1] neg_hi:[0,0,1]
    v_pk_fma_f32 v[124:125], v[124:125], v[154:155], v[152:153] op_sel_hi:[1,0,0] neg_lo:[0,0,1] neg_hi:[0,0,1]
    v_pk_fma_f32 v[126:127], v[126:127], v[154:155], v[152:153] op_sel_hi:[1,0,0] neg_lo:[0,0,1] neg_hi:[0,0,1]
    v_cvt_pk_bf16_f32 v148, v120, v121
    v_cvt_pk_bf16_f32 v149, v122, v123
    v_cvt_pk_bf16_f32 v150, v124, v125
    v_cvt_pk_bf16_f32 v151, v126, v127
    ds_write_b128 v4, v[148:151] offset:20480
    s_cmp_lg_u32 s22, 0
    s_cbranch_scc1 E_NP
    v_min_u32 v2, 17, v0
    v_lshlrev_b32 v2, 8, v2
    s_lshl_b32 s28, s21, 2
    s_mov_b64 exec, 0x3ffff
    s_cmp_lg_u32 s25, 0
    s_cbranch_scc1 Lsd4
    s_mov_b32 s29, 400000
Lsl3:
    buffer_load_dword v3, v2, s[4:7], s28 offen sc1
    s_waitcnt vmcnt(0)
    v_cmp_gt_u32 vcc, 1, v3
    s_nop 1
    s_cbranch_vccz Lsd4
    s_sub_u32 s29, s29, 1
    s_cbranch_scc0 Lsl3
    s_mov_b32 s25, 1
Lsd4:
    s_mov_b64 exec, -1
E_NP:
    s_waitcnt lgkmcnt(0)
    s_barrier
    s_mov_b32 s26, s40
    buffer_load_dwordx4 v[8:11], v1, s[4:7], s26 offen
    buffer_load_dwordx4 v[12:15], v1, s[4:7], s26 offen offset:1024
    buffer_load_dwordx4 v[16:19], v1, s[4:7], s26 offen offset:2048
    buffer_load_dwordx4 v[20:23], v1, s[4:7], s26 offen offset:3072
    s_add_u32 s26, s26, 4096
    buffer_load_dwordx4 v[24:27], v1, s[4:7], s26 offen
    buffer_load_dwordx4 v[28:31], v1, s[4:7], s26 offen offset:1024
    buffer_load_dwordx4 v[32:35], v1, s[4:7], s26 offen offset:2048
    buffer_load_dwordx4 v[36:39], v1, s[4:7], s26 offen offset:3072
    s_add_u32 s26, s26, 4096
    buffer_load_dwordx4 v[40:43], v1, s[4:7], s26 offen
    buffer_load_dwordx4 v[44:47], v1, s[4:7], s26 offen offset:1024
    buffer_load_dwordx4 v[48:51], v1, s[4:7], s26 offen offset:2048
    buffer_load_dwordx4 v[52:55], v1, s[4:7], s26 offen offset:3072
    s_add_u32 s26, s26, 4096
    buffer_load_dwordx4 v[56:59], v1, s[4:7], s26 offen
    buffer_load_dwordx4 v[60:63], v1, s[4:7], s26 offen offset:1024
    buffer_load_dwordx4 v[64:67], v1, s[4:7], s26 offen offset:2048
    buffer_load_dwordx4 v[68:71], v1, s[4:7], s26 offen offset:3072
    s_add_u32 s26, s26, 4096
    buffer_load_dwordx4 v[72:75], v1, s[4:7], s26 offen
    buffer_load_dwordx4 v[76:79], v1, s[4:7], s26 offen offset:1024
    s_branch A_GEMM
A_TOP:
    s_cmp_lg_u32 s22, 7
    s_cbranch_scc1 Lp5
    s_cmp_lg_u32 s25, 0
    s_cbranch_scc1 Lp5
    s_mov_b32 s30, 0xff
    s_mov_b32 s31, 0
    v_lshlrev_b32 v2, 2, v0
    s_lshl_b32 s28, s20, 8
    s_bitset0_b32 s30, s21
    s_add_u32 s27, s24, 0
    s_mov_b32 s29, 400000
    s_mov_b64 exec, s[30:31]
Lpl6:
    buffer_load_dword v3, v2, s[4:7], s28 offen sc1
    s_waitcnt vmcnt(0)
    v_cmp_gt_u32 vcc, s27, v3
    s_nop 1
    s_cbranch_vccz Lpd7
    s_sub_u32 s29, s29, 1
    s_cbranch_scc0 Lpl6
    s_mov_b32 s25, 1
Lpd7:
    s_mov_b64 exec, -1
Lp5:
    s_barrier
    s_mul_i32 s29, s20, 73728
    s_add_u32 s29, s29, 33341440
    s_lshr_b32 s27, s22, 2
    s_mul_i32 s27, s27, 24576
    s_and_b32 s28, s22, 3
    s_lshl_b32 s28, s28, 10
    s_add_u32 s27, s27, s28
    s_add_u32 s28, s27, s29
    buffer_load_dwordx4 v[128:131], v1, s[4:7], s28 offen sc1
    s_add_u32 s28, s28, 4096
    buffer_load_dwordx4 v[132:135], v1, s[4:7], s28 offen sc1
    s_add_u32 s28, s28, 4096
    buffer_load_dwordx4 v[136:139], v1, s[4:7], s28 offen sc1
    s_add_u32 s28, s28, 4096
    buffer_load_dwordx4 v[140:143], v1, s[4:7], s28 offen sc1
    s_add_u32 s28, s28, 4096
    buffer_load_dwordx4 v[144:147], v1, s[4:7], s28 offen sc1
    s_add_u32 s28, s28, 4096
    buffer_load_dwordx4 v[148:151], v1, s[4:7], s28 offen sc1
A_LN:
    s_and_b32 s27, s22, 3
    s_cmp_eq_u32 s27, 4
    s_cbranch_scc1 A_LN2
    s_cmp_lt_u32 s22, 5
    s_cbranch_scc1 A_LN2
    v_mov_b32 v156, 0x3f803f80
    v_mov_b32 v157, 0x3f803f80
    v_mov_b32 v158, 0x3f803f80
    v_mov_b32 v159, 0x3f803f80
    s_mov_b32 s27, 0xffff0000
    v_and_b32 v2, 15, v0
    s_and_b32 s28, s22, 3
    s_lshl_b32 s28, s28, 9
    s_add_u32 s28, s28, 156672
    v_lshl_add_u32 v2, v2, 5, s28
    s_lshr_b32 s28, s22, 2
    s_lshl_b32 s28, s28, 3
    v_add_u32 v3, s28, v2
    s_waitcnt vmcnt(5)
    v_mfma_f32_16x16x32_bf16 v[152:155], v[128:131], v[128:131], 0
    v_mfma_f32_16x16x32_bf16 v[4:7], v[156:159], v[128:131], 0
    v_lshlrev_b32 v80, 16, v128
    v_and_b32 v81, s27, v128
    v_lshlrev_b32 v82, 16, v129
    v_and_b32 v83, s27, v129
    v_lshlrev_b32 v84, 16, v130
    v_and_b32 v85, s27, v130
    v_lshlrev_b32 v86, 16, v131
    v_and_b32 v87, s27, v131
    s_mov_b32 s26, s40
    buffer_load_dwordx4 v[8:11], v1, s[4:7], s26 offen
    buffer_load_dwordx4 v[12:15], v1, s[4:7], s26 offen offset:1024
    s_waitcnt vmcnt(6)
    v_mfma_f32_16x16x32_bf16 v[152:155], v[132:135], v[132:135], v[152:155]
    v_mfma_f32_16x16x32_bf16 v[4:7], v[156:159], v[132:135], v[4:7]
    v_lshlrev_b32 v88, 16, v132
    v_and_b32 v89, s27, v132
    v_lshlrev_b32 v90, 16, v133
    v_and_b32 v91, s27, v133
    v_lshlrev_b32 v92, 16, v134
    v_and_b32 v93, s27, v134
    v_lshlrev_b32 v94, 16, v135
    v_and_b32 v95, s27, v135
    buffer_load_dwordx4 v[16:19], v1, s[4:7], s26 offen offset:2048
    buffer_load_dwordx4 v[20:23], v1, s[4:7], s26 offen offset:3072
    s_add_u32 s26, s26, 4096
    s_waitcnt vmcnt(7)
    v_mfma_f32_16x16x32_bf16 v[152:155], v[136:139], v[136:139], v[152:155]
    v_mfma_f32_16x16x32_bf16 v[4:7], v[156:159], v[136:139], v[4:7]
    buffer_load_dwordx4 v[24:27], v1, s[4:7], s26 offen
    buffer_load_dwordx4 v[28:31], v1, s[4:7], s26 offen offset:1024
    s_waitcnt vmcnt(8)
    v_mfma_f32_16x16x32_bf16 v[152:155], v[140:143], v[140:143], v[152:155]
    v_mfma_f32_16x16x32_bf16 v[4:7], v[156:159], v[140:143], v[4:7]
    buffer_load_dwordx4 v[32:35], v1, s[4:7], s26 offen offset:2048
    buffer_load_dwordx4 v[36:39], v1, s[4:7], s26 offen offset:3072
    s_add_u32 s26, s26, 4096
    s_waitcnt vmcnt(9)
    v_mfma_f32_16x16x32_bf16 v[152:155], v[144:147], v[144:147], v[152:155]
    v_mfma_f32_16x16x32_bf16 v[4:7], v[156:159], v[144:147], v[4:7]
    buffer_load_dwordx4 v[40:43], v1, s[4:7], s26 offen
    buffer_load_dwordx4 v[44:47], v1, s[4:7], s26 offen offset:1024
    s_waitcnt vmcnt(10)
    v_mfma_f32_16x16x32_bf16 v[152:155], v[148:151], v[148:151], v[152:155]
    v_mfma_f32_16x16x32_bf16 v[4:7], v[156:159], v[148:151], v[4:7]
    buffer_load_dwordx4 v[48:51], v1, s[4:7], s26 offen offset:2048
    buffer_load_dwordx4 v[52:55], v1, s[4:7], s26 offen offset:3072
    s_add_u32 s26, s26, 4096
    s_mov_b32 vcc_lo, 0xaaaaaaaa
    s_mov_b32 vcc_hi, 0xaaaaaaaa
    s_nop 1
    v_cndmask_b32 v152, v152, v153, vcc
    v_cndmask_b32 v154, v154, v155, vcc
    s_mov_b32 vcc_lo, 0xcccccccc
    s_mov_b32 vcc_hi, 0xcccccccc
    v_cndmask_b32 v5, v152, v154, vcc
    s_mov_b32 exec_lo, 0x00f0000f
    s_mov_b32 exec_hi, 0xf0000f00
    ds_write_b64 v3, v[4:5]
    s_mov_b64 exec, -1
    v_lshlrev_b32 v96, 16, v136
    v_and_b32 v97, s27, v136
    v_lshlrev_b32 v98, 16, v137
    v_and_b32 v99, s27, v137
    v_lshlrev_b32 v100, 16, v138
    v_and_b32 v101, s27, v138
    v_lshlrev_b32 v102, 16, v139
    v_and_b32 v103, s27, v139
    v_lshlrev_b32 v104, 16, v140
    v_and_b32 v105, s27, v140
    v_lshlrev_b32 v106, 16, v141
    v_and_b32 v107, s27, v141
    v_lshlrev_b32 v108, 16, v142
    v_and_b32 v109, s27, v142
    v_lshlrev_b32 v110, 16, v143
    v_and_b32 v111, s27, v143
    v_lshlrev_b32 v112, 16, v144
    v_and_b32 v113, s27, v144
    v_lshlrev_b32 v114, 16, v145
    v_and_b32 v115, s27, v145
    v_lshlrev_b32 v116, 16, v146
    v_and_b32 v117, s27, v146
    v_lshlrev_b32 v118, 16, v147
    v_and_b32 v119, s27, v147
    v_lshlrev_b32 v120, 16, v148
    v_and_b32 v121, s27, v148
    v_lshlrev_b32 v122, 16, v149
    v_and_b32 v123, s27, v149
    v_lshlrev_b32 v124, 16, v150
    v_and_b32 v125, s27, v150
    v_lshlrev_b32 v126, 16, v151
    v_and_b32 v127, s27, v151
    s_waitcnt lgkmcnt(0)
    s_barrier
    ds_read_b128 v[152:155], v2
    ds_read_b64 v[156:157], v2 offset:16
    s_lshr_b32 s27, s22, 2
    s_mul_i32 s27, s27, 24576
    s_and_b32 s28, s22, 3
    s_lshl_b32 s28, s28, 10
    s_add_u32 s27, s27, s28
    v_add_u32 v4, s27, v1
    s_mov_b32 s27, 0x3ae38e39
    s_mov_b32 s28, 0x3727c5ac
    s_waitcnt lgkmcnt(0)
    v_add_f32 v152, v152, v154
    v_add_f32 v153, v153, v155
    v_add_f32 v152, v152, v156
    v_add_f32 v153, v153, v157
    v_mul_f32 v152, s27, v152
    v_mul_f32 v153, s27, v153
    v_fma_f32 v153, -v152, v152, v153
    v_max_f32 v153, 0, v153
    v_add_f32 v154, s28, v153
    v_rsq_f32 v154, v154
    s_nop 0
    v_mul_f32 v152, v152, v154
    v_pk_fma_f32 v[80:81], v[80:81], v[154:155], v[152:153] op_sel_hi:[1,0,0] neg_lo:[0,0,1] neg_hi:[0,0,1]
    v_pk_fma_f32 v[82:83], v[82:83], v[154:155], v[152:153] op_sel_hi:[1,0,0] neg_lo:[0,0,1] neg_hi:[0,0,1]
    v_pk_fma_f32 v[84:85], v[84:85], v[154:155], v[152:153] op_sel_hi:[1,0,0] neg_lo:[0,0,1] neg_hi:[0,0,1]
    v_pk_fma_f32 v[86:87], v[86:87], v[154:155], v[152:153] op_sel_hi:[1,0,0] neg_lo:[0,0,1] neg_hi:[0,0,1]
    v_cvt_pk_bf16_f32 v128, v80, v81
    v_cvt_pk_bf16_f32 v129, v82, v83
    v_cvt_pk_bf16_f32 v130, v84, v85
    v_cvt_pk_bf16_f32 v131, v86, v87
    ds_write_b128 v4, v[128:131] offset:0
    buffer_load_dwordx4 v[56:59], v1, s[4:7], s26 offen
    v_pk_fma_f32 v[88:89], v[88:89], v[154:155], v[152:153] op_sel_hi:[1,0,0] neg_lo:[0,0,1] neg_hi:[0,0,1]
    v_pk_fma_f32 v[90:91], v[90:91], v[154:155], v[152:153] op_sel_hi:[1,0,0] neg_lo:[0,0,1] neg_hi:[0,0,1]
    v_pk_fma_f32 v[92:93], v[92:93], v[154:155], v[152:153] op_sel_hi:[1,0,0] neg_lo:[0,0,1] neg_hi:[0,0,1]
    v_pk_fma_f32 v[94:95], v[94:95], v[154:155], v[152:153] op_sel_hi:[1,0,0] neg_lo:[0,0,1] neg_hi:[0,0,1]
    v_cvt_pk_bf16_f32 v132, v88, v89
    v_cvt_pk_bf16_f32 v133, v90, v91
    v_cvt_pk_bf16_f32 v134, v92, v93
    v_cvt_pk_bf16_f32 v135, v94, v95
    ds_write_b128 v4, v[132:135] offset:4096
    buffer_load_dwordx4 v[60:63], v1, s[4:7], s26 offen offset:1024
    v_pk_fma_f32 v[96:97], v[96:97], v[154:155], v[152:153] op_sel_hi:[1,0,0] neg_lo:[0,0,1] neg_hi:[0,0,1]
    v_pk_fma_f32 v[98:99], v[98:99], v[154:155], v[152:153] op_sel_hi:[1,0,0] neg_lo:[0,0,1] neg_hi:[0,0,1]
    v_pk_fma_f32 v[100:101], v[100:101], v[154:155], v[152:153] op_sel_hi:[1,0,0] neg_lo:[0,0,1] neg_hi:[0,0,1]
    v_pk_fma_f32 v[102:103], v[102:103], v[154:155], v[152:153] op_sel_hi:[1,0,0] neg_lo:[0,0,1] neg_hi:[0,0,1]
    v_cvt_pk_bf16_f32 v136, v96, v97
    v_cvt_pk_bf16_f32 v137, v98, v99
    v_cvt_pk_bf16_f32 v138, v100, v101
    v_cvt_pk_bf16_f32 v139, v102, v103
    ds_write_b128 v4, v[136:139] offset:8192
    buffer_load_dwordx4 v[64:67], v1, s[4:7], s26 offen offset:2048
    v_pk_fma_f32 v[104:105], v[104:105], v[154:155], v[152:153] op_sel_hi:[1,0,0] neg_lo:[0,0,1] neg_hi:[0,0,1]
    v_pk_fma_f32 v[106:107], v[106:107], v[154:155], v[152:153] op_sel_hi:[1,0,0] neg_lo:[0,0,1] neg_hi:[0,0,1]
    v_pk_fma_f32 v[108:109], v[108:109], v[154:155], v[152:153] op_sel_hi:[1,0,0] neg_lo:[0,0,1] neg_hi:[0,0,1]
    v_pk_fma_f32 v[110:111], v[110:111], v[154:155], v[152:153] op_sel_hi:[1,0,0] neg_lo:[0,0,1] neg_hi:[0,0,1]
    v_cvt_pk_bf16_f32 v140, v104, v105
    v_cvt_pk_bf16_f32 v141, v106, v107
    v_cvt_pk_bf16_f32 v142, v108, v109
    v_cvt_pk_bf16_f32 v143, v110, v111
    ds_write_b128 v4, v[140:143] offset:12288
    buffer_load_dwordx4 v[68:71], v1, s[4:7], s26 offen offset:3072
    s_add_u32 s26, s26, 4096
    v_pk_fma_f32 v[112:113], v[112:113], v[154:155], v[152:153] op_sel_hi:[1,0,0] neg_lo:[0,0,1] neg_hi:[0,0,1]
    v_pk_fma_f32 v[114:115], v[114:115], v[154:155], v[152:153] op_sel_hi:[1,0,0] neg_lo:[0,0,1] neg_hi:[0,0,1]
    v_pk_fma_f32 v[116:117], v[116:117], v[154:155], v[152:153] op_sel_hi:[1,0,0] neg_lo:[0,0,1] neg_hi:[0,0,1]
    v_pk_fma_f32 v[118:119], v[118:119], v[154:155], v[152:153] op_sel_hi:[1,0,0] neg_lo:[0,0,1] neg_hi:[0,0,1]
    v_cvt_pk_bf16_f32 v144, v112, v113
    v_cvt_pk_bf16_f32 v145, v114, v115
    v_cvt_pk_bf16_f32 v146, v116, v117
    v_cvt_pk_bf16_f32 v147, v118, v119
    ds_write_b128 v4, v[144:147] offset:16384
    buffer_load_dwordx4 v[72:75], v1, s[4:7], s26 offen
    v_pk_fma_f32 v[120:121], v[120:121], v[154:155], v[152:153] op_sel_hi:[1,0,0] neg_lo:[0,0,1] neg_hi:[0,0,1]
    v_pk_fma_f32 v[122:123], v[122:123], v[154:155], v[152:153] op_sel_hi:[1,0,0] neg_lo:[0,0,1] neg_hi:[0,0,1]
    v_pk_fma_f32 v[124:125], v[124:125], v[154:155], v[152:153] op_sel_hi:[1,0,0] neg_lo:[0,0,1] neg_hi:[0,0,1]
    v_pk_fma_f32 v[126:127], v[126:127], v[154:155], v[152:153] op_sel_hi:[1,0,0] neg_lo:[0,0,1] neg_hi:[0,0,1]
    v_cvt_pk_bf16_f32 v148, v120, v121
    v_cvt_pk_bf16_f32 v149, v122, v123
    v_cvt_pk_bf16_f32 v150, v124, v125
    v_cvt_pk_bf16_f32 v151, v126, v127
    ds_write_b128 v4, v[148:151] offset:20480
    buffer_load_dwordx4 v[76:79], v1, s[4:7], s26 offen offset:1024
    s_branch A_LN3
A_LN2:
    v_mov_b32 v156, 0x3f803f80
    v_mov_b32 v157, 0x3f803f80
    v_mov_b32 v158, 0x3f803f80
    v_mov_b32 v159, 0x3f803f80
    s_mov_b32 s27, 0xffff0000
    v_and_b32 v2, 15, v0
    s_and_b32 s28, s22, 3
    s_lshl_b32 s28, s28, 9
    s_add_u32 s28, s28, 156672
    v_lshl_add_u32 v2, v2, 5, s28
    s_lshr_b32 s28, s22, 2
    s_lshl_b32 s28, s28, 3
    v_add_u32 v3, s28, v2
    s_waitcnt vmcnt(5)
    v_mfma_f32_16x16x32_bf16 v[152:155], v[128:131], v[128:131], 0
    v_mfma_f32_16x16x32_bf16 v[4:7], v[156:159], v[128:131], 0
    v_lshlrev_b32 v80, 16, v128
    v_and_b32 v81, s27, v128
    v_lshlrev_b32 v82, 16, v129
    v_and_b32 v83, s27, v129
    v_lshlrev_b32 v84, 16, v130
    v_and_b32 v85, s27, v130
    v_lshlrev_b32 v86, 16, v131
    v_and_b32 v87, s27, v131
    s_waitcnt vmcnt(4)
    v_mfma_f32_16x16x32_bf16 v[152:155], v[132:135], v[132:135], v[152:155]
    v_mfma_f32_16x16x32_bf16 v[4:7], v[156:159], v[132:135], v[4:7]
    v_lshlrev_b32 v88, 16, v132
    v_and_b32 v89, s27, v132
    v_lshlrev_b32 v90, 16, v133
    v_and_b32 v91, s27, v133
    v_lshlrev_b32 v92, 16, v134
    v_and_b32 v93, s27, v134
    v_lshlrev_b32 v94, 16, v135
    v_and_b32 v95, s27, v135
    s_waitcnt vmcnt(3)
    v_mfma_f32_16x16x32_bf16 v[152:155], v[136:139], v[136:139], v[152:155]
    v_mfma_f32_16x16x32_bf16 v[4:7], v[156:159], v[136:139], v[4:7]
    s_waitcnt vmcnt(2)
    v_mfma_f32_16x16x32_bf16 v[152:155], v[140:143], v[140:143], v[152:155]
    v_mfma_f32_16x16x32_bf16 v[4:7], v[156:159], v[140:143], v[4:7]
    s_waitcnt vmcnt(1)
    v_mfma_f32_16x16x32_bf16 v[152:155], v[144:147], v[144:147], v[152:155]
    v_mfma_f32_16x16x32_bf16 v[4:7], v[156:159], v[144:147], v[4:7]
    s_waitcnt vmcnt(0)
    v_mfma_f32_16x16x32_bf16 v[152:155], v[148:151], v[148:151], v[152:155]
    v_mfma_f32_16x16x32_bf16 v[4:7], v[156:159], v[148:151], v[4:7]
    s_mov_b32 vcc_lo, 0xaaaaaaaa
    s_mov_b32 vcc_hi, 0xaaaaaaaa
    s_nop 4
    v_cndmask_b32 v152, v152, v153, vcc
    v_cndmask_b32 v154, v154, v155, vcc
    s_mov_b32 vcc_lo, 0xcccccccc
    s_mov_b32 vcc_hi, 0xcccccccc
    v_cndmask_b32 v5, v152, v154, vcc
    s_mov_b32 exec_lo, 0x00f0000f
    s_mov_b32 exec_hi, 0xf0000f00
    ds_write_b64 v3, v[4:5]
    s_mov_b64 exec, -1
    v_lshlrev_b32 v96, 16, v136
    v_and_b32 v97, s27, v136
    v_lshlrev_b32 v98, 16, v137
    v_and_b32 v99, s27, v137
    v_lshlrev_b32 v100, 16, v138
    v_and_b32 v101, s27, v138
    v_lshlrev_b32 v102, 16, v139
    v_and_b32 v103, s27, v139
    v_lshlrev_b32 v104, 16, v140
    v_and_b32 v105, s27, v140
    v_lshlrev_b32 v106, 16, v141
    v_and_b32 v107, s27, v141
    v_lshlrev_b32 v108, 16, v142
    v_and_b32 v109, s27, v142
    v_lshlrev_b32 v110, 16, v143
    v_and_b32 v111, s27, v143
    v_lshlrev_b32 v112, 16, v144
    v_and_b32 v113, s27, v144
    v_lshlrev_b32 v114, 16, v145
    v_and_b32 v115, s27, v145
    v_lshlrev_b32 v116, 16, v146
    v_and_b32 v117, s27, v146
    v_lshlrev_b32 v118, 16, v147
    v_and_b32 v119, s27, v147
    v_lshlrev_b32 v120, 16, v148
    v_and_b32 v121, s27, v148
    v_lshlrev_b32 v122, 16, v149
    v_and_b32 v123, s27, v149
    v_lshlrev_b32 v124, 16, v150
    v_and_b32 v125, s27, v150
    v_lshlrev_b32 v126, 16, v151
    v_and_b32 v127, s27, v151
    s_waitcnt lgkmcnt(0)
    s_barrier
    ds_read_b128 v[152:155], v2
    ds_read_b64 v[156:157], v2 offset:16
    s_lshr_b32 s27, s22, 2
    s_mul_i32 s27, s27, 24576
    s_and_b32 s28, s22, 3
    s_lshl_b32 s28, s28, 10
    s_add_u32 s27, s27, s28
    v_add_u32 v4, s27, v1
    s_mov_b32 s27, 0x3ae38e39
    s_mov_b32 s28, 0x3727c5ac
    s_waitcnt lgkmcnt(0)
    v_add_f32 v152, v152, v154
    v_add_f32 v153, v153, v155
    v_add_f32 v152, v152, v156
    v_add_f32 v153, v153, v157
    v_mul_f32 v152, s27, v152
    v_mul_f32 v153, s27, v153
    v_fma_f32 v153, -v152, v152, v153
    v_max_f32 v153, 0, v153
    v_add_f32 v154, s28, v153
    v_rsq_f32 v154, v154
    s_nop 0
    v_mul_f32 v152, v152, v154
    v_pk_fma_f32 v[80:81], v[80:81], v[154:155], v[152:153] op_sel_hi:[1,0,0] neg_lo:[0,0,1] neg_hi:[0,0,1]
    v_pk_fma_f32 v[82:83], v[82:83], v[154:155], v[152:153] op_sel_hi:[1,0,0] neg_lo:[0,0,1] neg_hi:[0,0,1]
    v_pk_fma_f32 v[84:85], v[84:85], v[154:155], v[152:153] op_sel_hi:[1,0,0] neg_lo:[0,0,1] neg_hi:[0,0,1]
    v_pk_fma_f32 v[86:87], v[86:87], v[154:155], v[152:153] op_sel_hi:[1,0,0] neg_lo:[0,0,1] neg_hi:[0,0,1]
    v_cvt_pk_bf16_f32 v128, v80, v81
    v_cvt_pk_bf16_f32 v129, v82, v83
    v_cvt_pk_bf16_f32 v130, v84, v85
    v_cvt_pk_bf16_f32 v131, v86, v87
    ds_write_b128 v4, v[128:131] offset:0
    v_pk_fma_f32 v[88:89], v[88:89], v[154:155], v[152:153] op_sel_hi:[1,0,0] neg_lo:[0,0,1] neg_hi:[0,0,1]
    v_pk_fma_f32 v[90:91], v[90:91], v[154:155], v[152:153] op_sel_hi:[1,0,0] neg_lo:[0,0,1] neg_hi:[0,0,1]
    v_pk_fma_f32 v[92:93], v[92:93], v[154:155], v[152:153] op_sel_hi:[1,0,0] neg_lo:[0,0,1] neg_hi:[0,0,1]
    v_pk_fma_f32 v[94:95], v[94:95], v[154:155], v[152:153] op_sel_hi:[1,0,0] neg_lo:[0,0,1] neg_hi:[0,0,1]
    v_cvt_pk_bf16_f32 v132, v88, v89
    v_cvt_pk_bf16_f32 v133, v90, v91
    v_cvt_pk_bf16_f32 v134, v92, v93
    v_cvt_pk_bf16_f32 v135, v94, v95
    ds_write_b128 v4, v[132:135] offset:4096
    v_pk_fma_f32 v[96:97], v[96:97], v[154:155], v[152:153] op_sel_hi:[1,0,0] neg_lo:[0,0,1] neg_hi:[0,0,1]
    v_pk_fma_f32 v[98:99], v[98:99], v[154:155], v[152:153] op_sel_hi:[1,0,0] neg_lo:[0,0,1] neg_hi:[0,0,1]
    v_pk_fma_f32 v[100:101], v[100:101], v[154:155], v[152:153] op_sel_hi:[1,0,0] neg_lo:[0,0,1] neg_hi:[0,0,1]
    v_pk_fma_f32 v[102:103], v[102:103], v[154:155], v[152:153] op_sel_hi:[1,0,0] neg_lo:[0,0,1] neg_hi:[0,0,1]
    v_cvt_pk_bf16_f32 v136, v96, v97
    v_cvt_pk_bf16_f32 v137, v98, v99
    v_cvt_pk_bf16_f32 v138, v100, v101
    v_cvt_pk_bf16_f32 v139, v102, v103
    ds_write_b128 v4, v[136:139] offset:8192
    v_pk_fma_f32 v[104:105], v[104:105], v[154:155], v[152:153] op_sel_hi:[1,0,0] neg_lo:[0,0,1] neg_hi:[0,0,1]
    v_pk_fma_f32 v[106:107], v[106:107], v[154:155], v[152:153] op_sel_hi:[1,0,0] neg_lo:[0,0,1] neg_hi:[0,0,1]
    v_pk_fma_f32 v[108:109], v[108:109], v[154:155], v[152:153] op_sel_hi:[1,0,0] neg_lo:[0,0,1] neg_hi:[0,0,1]
    v_pk_fma_f32 v[110:111], v[110:111], v[154:155], v[152:153] op_sel_hi:[1,0,0] neg_lo:[0,0,1] neg_hi:[0,0,1]
    v_cvt_pk_bf16_f32 v140, v104, v105
    v_cvt_pk_bf16_f32 v141, v106, v107
    v_cvt_pk_bf16_f32 v142, v108, v109
    v_cvt_pk_bf16_f32 v143, v110, v111
    ds_write_b128 v4, v[140:143] offset:12288
    v_pk_fma_f32 v[112:113], v[112:113], v[154:155], v[152:153] op_sel_hi:[1,0,0] neg_lo:[0,0,1] neg_hi:[0,0,1]
    v_pk_fma_f32 v[114:115], v[114:115], v[154:155], v[152:153] op_sel_hi:[1,0,0] neg_lo:[0,0,1] neg_hi:[0,0,1]
    v_pk_fma_f32 v[116:117], v[116:117], v[154:155], v[152:153] op_sel_hi:[1,0,0] neg_lo:[0,0,1] neg_hi:[0,0,1]
    v_pk_fma_f32 v[118:119], v[118:119], v[154:155], v[152:153] op_sel_hi:[1,0,0] neg_lo:[0,0,1] neg_hi:[0,0,1]
    v_cvt_pk_bf16_f32 v144, v112, v113
    v_cvt_pk_bf16_f32 v145, v114, v115
    v_cvt_pk_bf16_f32 v146, v116, v117
    v_cvt_pk_bf16_f32 v147, v118, v119
    ds_write_b128 v4, v[144:147] offset:16384
    v_pk_fma_f32 v[120:121], v[120:121], v[154:155], v[152:153] op_sel_hi:[1,0,0] neg_lo:[0,0,1] neg_hi:[0,0,1]
    v_pk_fma_f32 v[122:123], v[122:123], v[154:155], v[152:153] op_sel_hi:[1,0,0] neg_lo:[0,0,1] neg_hi:[0,0,1]
    v_pk_fma_f32 v[124:125], v[124:125], v[154:155], v[152:153] op_sel_hi:[1,0,0] neg_lo:[0,0,1] neg_hi:[0,0,1]
    v_pk_fma_f32 v[126:127], v[126:127], v[154:155], v[152:153] op_sel_hi:[1,0,0] neg_lo:[0,0,1] neg_hi:[0,0,1]
    v_cvt_pk_bf16_f32 v148, v120, v121
    v_cvt_pk_bf16_f32 v149, v122, v123
    v_cvt_pk_bf16_f32 v150, v124, v125
    v_cvt_pk_bf16_f32 v151, v126, v127
    ds_write_b128 v4, v[148:151] offset:20480
A_LN3:
    s_waitcnt lgkmcnt(0)
    s_barrier
A_GEMM:
    s_lshl_b32 s36, s21, 6
    s_lshl_b32 s96, s20, 1
    s_add_u32 s36, s36, s96
    s_mul_i32 s36, s36, 9216
    s_mul_i32 s96, s23, 4718592
    s_add_u32 s36, s36, s96
    s_add_u32 s36, s36, 14467072
    s_cmp_ge_u32 s22, 8
    s_cbranch_scc1 A_HALF
    s_cmp_ge_u32 s22, 4
    s_cbranch_scc1 A_V
    s_setprio 2
    v_add_u32 v6, 0, v1
    v_add_u32 v7, 36864, v6
    s_add_u32 s26, s40, 16384
    ds_read_b128 v[128:131], v6 offset:0
    ds_read_b128 v[132:135], v6 offset:1024
    ds_read_b128 v[136:139], v6 offset:2048
    ds_read_b128 v[140:143], v6 offset:3072
    ds_read_b128 v[144:147], v6 offset:4096
    ds_read_b128 v[148:151], v6 offset:5120
    ds_read_b128 v[152:155], v6 offset:6144
    ds_read_b128 v[156:159], v6 offset:7168
    s_waitcnt vmcnt(17) lgkmcnt(4)
    v_mfma_f32_16x16x32_bf16 v[80:83], v[8:11], v[128:131], 0
    v_mfma_f32_16x16x32_bf16 v[84:87], v[8:11], v[132:135], 0
    v_mfma_f32_16x16x32_bf16 v[88:91], v[8:11], v[136:139], 0
    v_mfma_f32_16x16x32_bf16 v[92:95], v[8:11], v[140:143], 0
    buffer_load_dwordx4 v[8:11], v1, s[4:7], s26 offen offset:2048
    ds_read_b128 v[128:131], v6 offset:8192
    ds_read_b128 v[132:135], v6 offset:9216
    ds_read_b128 v[136:139], v6 offset:10240
    ds_read_b128 v[140:143], v6 offset:11264
    s_waitcnt vmcnt(17) lgkmcnt(4)
    v_mfma_f32_16x16x32_bf16 v[80:83], v[12:15], v[144:147], v[80:83]
    v_mfma_f32_16x16x32_bf16 v[84:87], v[12:15], v[148:151], v[84:87]
    v_mfma_f32_16x16x32_bf16 v[88:91], v[12:15], v[152:155], v[88:91]
    v_mfma_f32_16x16x32_bf16 v[92:95], v[12:15], v[156:159], v[92:95]
    buffer_load_dwordx4 v[12:15], v1, s[4:7], s26 offen offset:3072
    s_add_u32 s26, s26, 4096
    ds_read_b128 v[144:147], v6 offset:12288
    ds_read_b128 v[148:151], v6 offset:13312
    ds_read_b128 v[152:155], v6 offset:14336
    ds_read_b128 v[156:159], v6 offset:15360
    s_waitcnt vmcnt(17) lgkmcnt(4)
    v_mfma_f32_16x16x32_bf16 v[80:83], v[16:19], v[128:131], v[80:83]
    v_mfma_f32_16x16x32_bf16 v[84:87], v[16:19], v[132:135], v[84:87]
    v_mfma_f32_16x16x32_bf16 v[88:91], v[16:19], v[136:139], v[88:91]
    v_mfma_f32_16x16x32_bf16 v[92:95], v[16:19], v[140:143], v[92:95]
    buffer_load_dwordx4 v[16:19], v1, s[4:7], s26 offen
    ds_read_b128 v[128:131], v6 offset:16384
    ds_read_b128 v[132:135], v6 offset:17408
    ds_read_b128 v[136:139], v6 offset:18432
    ds_read_b128 v[140:143], v6 offset:19456
    s_waitcnt vmcnt(17) lgkmcnt(4)
    v_mfma_f32_16x16x32_bf16 v[80:83], v[20:23], v[144:147], v[80:83]
    v_mfma_f32_16x16x32_bf16 v[84:87], v[20:23], v[148:151], v[84:87]
    v_mfma_f32_16x16x32_bf16 v[88:91], v[20:23], v[152:155], v[88:91]
    v_mfma_f32_16x16x32_bf16 v[92:95], v[20:23], v[156:159], v[92:95]
    buffer_load_dwordx4 v[20:23], v1, s[4:7], s26 offen offset:1024
    ds_read_b128 v[144:147], v6 offset:20480
    ds_read_b128 v[148:151], v6 offset:21504
    ds_read_b128 v[152:155], v6 offset:22528
    ds_read_b128 v[156:159], v6 offset:23552
    s_waitcnt vmcnt(17) lgkmcnt(4)
    v_mfma_f32_16x16x32_bf16 v[80:83], v[24:27], v[128:131], v[80:83]
    v_mfma_f32_16x16x32_bf16 v[84:87], v[24:27], v[132:135], v[84:87]
    v_mfma_f32_16x16x32_bf16 v[88:91], v[24:27], v[136:139], v[88:91]
    v_mfma_f32_16x16x32_bf16 v[92:95], v[24:27], v[140:143], v[92:95]
    buffer_load_dwordx4 v[24:27], v1, s[4:7], s26 offen offset:2048
    ds_read_b128 v[128:131], v6 offset:24576
    ds_read_b128 v[132:135], v6 offset:25600
    ds_read_b128 v[136:139], v6 offset:26624
    ds_read_b128 v[140:143], v6 offset:27648
    s_waitcnt vmcnt(17) lgkmcnt(4)
    v_mfma_f32_16x16x32_bf16 v[80:83], v[28:31], v[144:147], v[80:83]
    v_mfma_f32_16x16x32_bf16 v[84:87], v[28:31], v[148:151], v[84:87]
    v_mfma_f32_16x16x32_bf16 v[88:91], v[28:31], v[152:155], v[88:91]
    v_mfma_f32_16x16x32_bf16 v[92:95], v[28:31], v[156:159], v[92:95]
    buffer_load_dwordx4 v[28:31], v1, s[4:7], s26 offen offset:3072
    s_add_u32 s26, s26, 4096
    ds_read_b128 v[144:147], v6 offset:28672
    ds_read_b128 v[148:151], v6 offset:29696
    ds_read_b128 v[152:155], v6 offset:30720
    ds_read_b128 v[156:159], v6 offset:31744
    s_waitcnt vmcnt(17) lgkmcnt(4)
    v_mfma_f32_16x16x32_bf16 v[80:83], v[32:35], v[128:131], v[80:83]
    v_mfma_f32_16x16x32_bf16 v[84:87], v[32:35], v[132:135], v[84:87]
    v_mfma_f32_16x16x32_bf16 v[88:91], v[32:35], v[136:139], v[88:91]
    v_mfma_f32_16x16x32_bf16 v[92:95], v[32:35], v[140:143], v[92:95]
    buffer_load_dwordx4 v[32:35], v1, s[4:7], s26 offen
    ds_read_b128 v[128:131], v6 offset:32768
    ds_read_b128 v[132:135], v6 offset:33792
    ds_read_b128 v[136:139], v6 offset:34816
    ds_read_b128 v[140:143], v6 offset:35840
    s_waitcnt vmcnt(17) lgkmcnt(4)
    v_mfma_f32_16x16x32_bf16 v[80:83], v[36:39], v[144:147], v[80:83]
    v_mfma_f32_16x16x32_bf16 v[84:87], v[36:39], v[148:151], v[84:87]
    v_mfma_f32_16x16x32_bf16 v[88:91], v[36:39], v[152:155], v[88:91]
    v_mfma_f32_16x16x32_bf16 v[92:95], v[36:39], v[156:159], v[92:95]
    buffer_load_dwordx4 v[36:39], v1, s[4:7], s26 offen offset:1024
    ds_read_b128 v[144:147], v7 offset:0
    ds_read_b128 v[148:151], v7 offset:1024
    ds_read_b128 v[152:155], v7 offset:2048
    ds_read_b128 v[156:159], v7 offset:3072
    s_waitcnt vmcnt(17) lgkmcnt(4)
    v_mfma_f32_16x16x32_bf16 v[80:83], v[40:43], v[128:131], v[80:83]
    v_mfma_f32_16x16x32_bf16 v[84:87], v[40:43], v[132:135], v[84:87]
    v_mfma_f32_16x16x32_bf16 v[88:91], v[40:43], v[136:139], v[88:91]
    v_mfma_f32_16x16x32_bf16 v[92:95], v[40:43], v[140:143], v[92:95]
    buffer_load_dwordx4 v[40:43], v1, s[4:7], s26 offen offset:2048
    ds_read_b128 v[128:131], v7 offset:4096
    ds_read_b128 v[132:135], v7 offset:5120
    ds_read_b128 v[136:139], v7 offset:6144
    ds_read_b128 v[140:143], v7 offset:7168
    s_waitcnt vmcnt(17) lgkmcnt(4)
    v_mfma_f32_16x16x32_bf16 v[80:83], v[44:47], v[144:147], v[80:83]
    v_mfma_f32_16x16x32_bf16 v[84:87], v[44:47], v[148:151], v[84:87]
    v_mfma_f32_16x16x32_bf16 v[88:91], v[44:47], v[152:155], v[88:91]
    v_mfma_f32_16x16x32_bf16 v[92:95], v[44:47], v[156:159], v[92:95]
    buffer_load_dwordx4 v[44:47], v1, s[4:7], s26 offen offset:3072
    s_add_u32 s26, s26, 4096
    ds_read_b128 v[144:147], v7 offset:8192
    ds_read_b128 v[148:151], v7 offset:9216
    ds_read_b128 v[152:155], v7 offset:10240
    ds_read_b128 v[156:159], v7 offset:11264
    s_waitcnt vmcnt(17) lgkmcnt(4)
    v_mfma_f32_16x16x32_bf16 v[80:83], v[48:51], v[128:131], v[80:83]
    v_mfma_f32_16x16x32_bf16 v[84:87], v[48:51], v[132:135], v[84:87]
    v_mfma_f32_16x16x32_bf16 v[88:91], v[48:51], v[136:139], v[88:91]
    v_mfma_f32_16x16x32_bf16 v[92:95], v[48:51], v[140:143], v[92:95]
    buffer_load_dwordx4 v[48:51], v1, s[4:7], s26 offen
    ds_read_b128 v[128:131], v7 offset:12288
    ds_read_b128 v[132:135], v7 offset:13312
    ds_read_b128 v[136:139], v7 offset:14336
    ds_read_b128 v[140:143], v7 offset:15360
    s_waitcnt vmcnt(17) lgkmcnt(4)
    v_mfma_f32_16x16x32_bf16 v[80:83], v[52:55], v[144:147], v[80:83]
    v_mfma_f32_16x16x32_bf16 v[84:87], v[52:55], v[148:151], v[84:87]
    v_mfma_f32_16x16x32_bf16 v[88:91], v[52:55], v[152:155], v[88:91]
    v_mfma_f32_16x16x32_bf16 v[92:95], v[52:55], v[156:159], v[92:95]
    buffer_load_dwordx4 v[52:55], v1, s[4:7], s26 offen offset:1024
    ds_read_b128 v[144:147], v7 offset:16384
    ds_read_b128 v[148:151], v7 offset:17408
    ds_read_b128 v[152:155], v7 offset:18432
    ds_read_b128 v[156:159], v7 offset:19456
    s_waitcnt vmcnt(17) lgkmcnt(4)
    v_mfma_f32_16x16x32_bf16 v[80:83], v[56:59], v[128:131], v[80:83]
    v_mfma_f32_16x16x32_bf16 v[84:87], v[56:59], v[132:135], v[84:87]
    v_mfma_f32_16x16x32_bf16 v[88:91], v[56:59], v[136:139], v[88:91]
    v_mfma_f32_16x16x32_bf16 v[92:95], v[56:59], v[140:143], v[92:95]
    buffer_load_dwordx4 v[56:59], v1, s[4:7], s26 offen offset:2048
    ds_read_b128 v[128:131], v7 offset:20480
    ds_read_b128 v[132:135], v7 offset:21504
    ds_read_b128 v[136:139], v7 offset:22528
    ds_read_b128 v[140:143], v7 offset:23552
    s_waitcnt vmcnt(17) lgkmcnt(4)
    v_mfma_f32_16x16x32_bf16 v[80:83], v[60:63], v[144:147], v[80:83]
    v_mfma_f32_16x16x32_bf16 v[84:87], v[60:63], v[148:151], v[84:87]
    v_mfma_f32_16x16x32_bf16 v[88:91], v[60:63], v[152:155], v[88:91]
    v_mfma_f32_16x16x32_bf16 v[92:95], v[60:63], v[156:159], v[92:95]
    buffer_load_dwordx4 v[60:63], v1, s[4:7], s26 offen offset:3072
    s_add_u32 s26, s26, 4096
    ds_read_b128 v[144:147], v7 offset:24576
    ds_read_b128 v[148:151], v7 offset:25600
    ds_read_b128 v[152:155], v7 offset:26624
    ds_read_b128 v[156:159], v7 offset:27648
    s_waitcnt vmcnt(17) lgkmcnt(4)
    v_mfma_f32_16x16x32_bf16 v[80:83], v[64:67], v[128:131], v[80:83]
    v_mfma_f32_16x16x32_bf16 v[84:87], v[64:67], v[132:135], v[84:87]
    v_mfma_f32_16x16x32_bf16 v[88:91], v[64:67], v[136:139], v[88:91]
    v_mfma_f32_16x16x32_bf16 v[92:95], v[64:67], v[140:143], v[92:95]
    buffer_load_dwordx4 v[64:67], v1, s[4:7], s26 offen
    ds_read_b128 v[128:131], v7 offset:28672
    ds_read_b128 v[132:135], v7 offset:29696
    ds_read_b128 v[136:139], v7 offset:30720
    ds_read_b128 v[140:143], v7 offset:31744
    s_waitcnt vmcnt(17) lgkmcnt(4)
    v_mfma_f32_16x16x32_bf16 v[80:83], v[68:71], v[144:147], v[80:83]
    v_mfma_f32_16x16x32_bf16 v[84:87], v[68:71], v[148:151], v[84:87]
    v_mfma_f32_16x16x32_bf16 v[88:91], v[68:71], v[152:155], v[88:91]
    v_mfma_f32_16x16x32_bf16 v[92:95], v[68:71], v[156:159], v[92:95]
    buffer_load_dwordx4 v[68:71], v1, s[4:7], s26 offen offset:1024
    ds_read_b128 v[144:147], v7 offset:32768
    ds_read_b128 v[148:151], v7 offset:33792
    ds_read_b128 v[152:155], v7 offset:34816
    ds_read_b128 v[156:159], v7 offset:35840
    s_waitcnt vmcnt(17) lgkmcnt(4)
    v_mfma_f32_16x16x32_bf16 v[80:83], v[72:75], v[128:131], v[80:83]
    v_mfma_f32_16x16x32_bf16 v[84:87], v[72:75], v[132:135], v[84:87]
    v_mfma_f32_16x16x32_bf16 v[88:91], v[72:75], v[136:139], v[88:91]
    v_mfma_f32_16x16x32_bf16 v[92:95], v[72:75], v[140:143], v[92:95]
    buffer_load_dwordx4 v[72:75], v1, s[4:7], s26 offen offset:2048
    s_waitcnt vmcnt(17) lgkmcnt(0)
    v_mfma_f32_16x16x32_bf16 v[80:83], v[76:79], v[144:147], v[80:83]
    v_mfma_f32_16x16x32_bf16 v[84:87], v[76:79], v[148:151], v[84:87]
    v_mfma_f32_16x16x32_bf16 v[88:91], v[76:79], v[152:155], v[88:91]
    v_mfma_f32_16x16x32_bf16 v[92:95], v[76:79], v[156:159], v[92:95]
    buffer_load_dwordx4 v[76:79], v1, s[4:7], s26 offen offset:3072
    s_add_u32 s26, s26, 4096
    v_lshrrev_b32 v2, 3, v0
    v_lshrrev_b32 v3, 4, v0
    v_xor_b32 v2, v2, v3
    v_and_b32 v2, 1, v2
    v_mul_u32_u24 v2, 24, v2
    v_xor_b32 v2, v2, v0
    v_lshlrev_b32 v2, 4, v2
    s_mul_i32 s27, s22, 2304
    s_add_u32 s36, s36, s27
    s_add_u32 s37, s36, 9216
    v_cvt_pk_bf16_f32 v112, v80, v81
    v_cvt_pk_bf16_f32 v114, v84, v85
    v_cvt_pk_bf16_f32 v113, v82, v83
    v_cvt_pk_bf16_f32 v115, v86, v87
    v_permlane16_swap_b32 v112, v114
    s_nop 0
    v_permlane16_swap_b32 v113, v115
    buffer_store_dwordx4 v[112:115], v2, s[4:7], s36 offen sc1
    v_cvt_pk_bf16_f32 v116, v88, v89
    v_cvt_pk_bf16_f32 v118, v92, v93
    v_cvt_pk_bf16_f32 v117, v90, v91
    v_cvt_pk_bf16_f32 v119, v94, v95
    v_permlane16_swap_b32 v116, v118
    s_nop 0
    v_permlane16_swap_b32 v117, v119
    buffer_store_dwordx4 v[116:119], v2, s[4:7], s37 offen sc1
    s_setprio 0
    s_branch A_DONE
A_V:
    v_add_u32 v6, 0, v1
    v_add_u32 v7, 36864, v6
    ds_read_b128 v[128:131], v6 offset:0
    ds_read_b128 v[132:135], v6 offset:1024
    ds_read_b128 v[136:139], v6 offset:2048
    ds_read_b128 v[140:143], v6 offset:3072
    ds_read_b128 v[144:147], v6 offset:4096
    ds_read_b128 v[148:151], v6 offset:5120
    ds_read_b128 v[152:155], v6 offset:6144
    ds_read_b128 v[156:159], v6 offset:7168
    s_waitcnt vmcnt(17) lgkmcnt(4)
    v_mfma_f32_16x16x32_bf16 v[80:83], v[128:131], v[8:11], 0
    v_mfma_f32_16x16x32_bf16 v[84:87], v[132:135], v[8:11], 0
    v_mfma_f32_16x16x32_bf16 v[88:91], v[136:139], v[8:11], 0
    v_mfma_f32_16x16x32_bf16 v[92:95], v[140:143], v[8:11], 0
    ds_read_b128 v[128:131], v6 offset:8192
    ds_read_b128 v[132:135], v6 offset:9216
    ds_read_b128 v[136:139], v6 offset:10240
    ds_read_b128 v[140:143], v6 offset:11264
    s_waitcnt vmcnt(16) lgkmcnt(4)
    v_mfma_f32_16x16x32_bf16 v[80:83], v[144:147], v[12:15], v[80:83]
    v_mfma_f32_16x16x32_bf16 v[84:87], v[148:151], v[12:15], v[84:87]
    v_mfma_f32_16x16x32_bf16 v[88:91], v[152:155], v[12:15], v[88:91]
    v_mfma_f32_16x16x32_bf16 v[92:95], v[156:159], v[12:15], v[92:95]
    ds_read_b128 v[144:147], v6 offset:12288
    ds_read_b128 v[148:151], v6 offset:13312
    ds_read_b128 v[152:155], v6 offset:14336
    ds_read_b128 v[156:159], v6 offset:15360
    s_waitcnt vmcnt(15) lgkmcnt(4)
    v_mfma_f32_16x16x32_bf16 v[80:83], v[128:131], v[16:19], v[80:83]
    v_mfma_f32_16x16x32_bf16 v[84:87], v[132:135], v[16:19], v[84:87]
    v_mfma_f32_16x16x32_bf16 v[88:91], v[136:139], v[16:19], v[88:91]
    v_mfma_f32_16x16x32_bf16 v[92:95], v[140:143], v[16:19], v[92:95]
    ds_read_b128 v[128:131], v6 offset:16384
    ds_read_b128 v[132:135], v6 offset:17408
    ds_read_b128 v[136:139], v6 offset:18432
    ds_read_b128 v[140:143], v6 offset:19456
    s_waitcnt vmcnt(14) lgkmcnt(4)
    v_mfma_f32_16x16x32_bf16 v[80:83], v[144:147], v[20:23], v[80:83]
    v_mfma_f32_16x16x32_bf16 v[84:87], v[148:151], v[20:23], v[84:87]
    v_mfma_f32_16x16x32_bf16 v[88:91], v[152:155], v[20:23], v[88:91]
    v_mfma_f32_16x16x32_bf16 v[92:95], v[156:159], v[20:23], v[92:95]
    ds_read_b128 v[144:147], v6 offset:20480
    ds_read_b128 v[148:151], v6 offset:21504
    ds_read_b128 v[152:155], v6 offset:22528
    ds_read_b128 v[156:159], v6 offset:23552
    s_waitcnt vmcnt(13) lgkmcnt(4)
    v_mfma_f32_16x16x32_bf16 v[80:83], v[128:131], v[24:27], v[80:83]
    v_mfma_f32_16x16x32_bf16 v[84:87], v[132:135], v[24:27], v[84:87]
    v_mfma_f32_16x16x32_bf16 v[88:91], v[136:139], v[24:27], v[88:91]
    v_mfma_f32_16x16x32_bf16 v[92:95], v[140:143], v[24:27], v[92:95]
    ds_read_b128 v[128:131], v6 offset:24576
    ds_read_b128 v[132:135], v6 offset:25600
    ds_read_b128 v[136:139], v6 offset:26624
    ds_read_b128 v[140:143], v6 offset:27648
    s_waitcnt vmcnt(12) lgkmcnt(4)
    v_mfma_f32_16x16x32_bf16 v[80:83], v[144:147], v[28:31], v[80:83]
    v_mfma_f32_16x16x32_bf16 v[84:87], v[148:151], v[28:31], v[84:87]
    v_mfma_f32_16x16x32_bf16 v[88:91], v[152:155], v[28:31], v[88:91]
    v_mfma_f32_16x16x32_bf16 v[92:95], v[156:159], v[28:31], v[92:95]
    ds_read_b128 v[144:147], v6 offset:28672
    ds_read_b128 v[148:151], v6 offset:29696
    ds_read_b128 v[152:155], v6 offset:30720
    ds_read_b128 v[156:159], v6 offset:31744
    s_waitcnt vmcnt(11) lgkmcnt(4)
    v_mfma_f32_16x16x32_bf16 v[80:83], v[128:131], v[32:35], v[80:83]
    v_mfma_f32_16x16x32_bf16 v[84:87], v[132:135], v[32:35], v[84:87]
    v_mfma_f32_16x16x32_bf16 v[88:91], v[136:139], v[32:35], v[88:91]
    v_mfma_f32_16x16x32_bf16 v[92:95], v[140:143], v[32:35], v[92:95]
    ds_read_b128 v[128:131], v6 offset:32768
    ds_read_b128 v[132:135], v6 offset:33792
    ds_read_b128 v[136:139], v6 offset:34816
    ds_read_b128 v[140:143], v6 offset:35840
    s_waitcnt vmcnt(10) lgkmcnt(4)
    v_mfma_f32_16x16x32_bf16 v[80:83], v[144:147], v[36:39], v[80:83]
    v_mfma_f32_16x16x32_bf16 v[84:87], v[148:151], v[36:39], v[84:87]
    v_mfma_f32_16x16x32_bf16 v[88:91], v[152:155], v[36:39], v[88:91]
    v_mfma_f32_16x16x32_bf16 v[92:95], v[156:159], v[36:39], v[92:95]
    ds_read_b128 v[144:147], v7 offset:0
    ds_read_b128 v[148:151], v7 offset:1024
    ds_read_b128 v[152:155], v7 offset:2048
    ds_read_b128 v[156:159], v7 offset:3072
    s_waitcnt vmcnt(9) lgkmcnt(4)
    v_mfma_f32_16x16x32_bf16 v[80:83], v[128:131], v[40:43], v[80:83]
    v_mfma_f32_16x16x32_bf16 v[84:87], v[132:135], v[40:43], v[84:87]
    v_mfma_f32_16x16x32_bf16 v[88:91], v[136:139], v[40:43], v[88:91]
    v_mfma_f32_16x16x32_bf16 v[92:95], v[140:143], v[40:43], v[92:95]
    ds_read_b128 v[128:131], v7 offset:4096
    ds_read_b128 v[132:135], v7 offset:5120
    ds_read_b128 v[136:139], v7 offset:6144
    ds_read_b128 v[140:143], v7 offset:7168
    s_waitcnt vmcnt(8) lgkmcnt(4)
    v_mfma_f32_16x16x32_bf16 v[80:83], v[144:147], v[44:47], v[80:83]
    v_mfma_f32_16x16x32_bf16 v[84:87], v[148:151], v[44:47], v[84:87]
    v_mfma_f32_16x16x32_bf16 v[88:91], v[152:155], v[44:47], v[88:91]
    v_mfma_f32_16x16x32_bf16 v[92:95], v[156:159], v[44:47], v[92:95]
    ds_read_b128 v[144:147], v7 offset:8192
    ds_read_b128 v[148:151], v7 offset:9216
    ds_read_b128 v[152:155], v7 offset:10240
    ds_read_b128 v[156:159], v7 offset:11264
    s_waitcnt vmcnt(7) lgkmcnt(4)
    v_mfma_f32_16x16x32_bf16 v[80:83], v[128:131], v[48:51], v[80:83]
    v_mfma_f32_16x16x32_bf16 v[84:87], v[132:135], v[48:51], v[84:87]
    v_mfma_f32_16x16x32_bf16 v[88:91], v[136:139], v[48:51], v[88:91]
    v_mfma_f32_16x16x32_bf16 v[92:95], v[140:143], v[48:51], v[92:95]
    ds_read_b128 v[128:131], v7 offset:12288
    ds_read_b128 v[132:135], v7 offset:13312
    ds_read_b128 v[136:139], v7 offset:14336
    ds_read_b128 v[140:143], v7 offset:15360
    s_waitcnt vmcnt(6) lgkmcnt(4)
    v_mfma_f32_16x16x32_bf16 v[80:83], v[144:147], v[52:55], v[80:83]
    v_mfma_f32_16x16x32_bf16 v[84:87], v[148:151], v[52:55], v[84:87]
    v_mfma_f32_16x16x32_bf16 v[88:91], v[152:155], v[52:55], v[88:91]
    v_mfma_f32_16x16x32_bf16 v[92:95], v[156:159], v[52:55], v[92:95]
    ds_read_b128 v[144:147], v7 offset:16384
    ds_read_b128 v[148:151], v7 offset:17408
    ds_read_b128 v[152:155], v7 offset:18432
    ds_read_b128 v[156:159], v7 offset:19456
    s_waitcnt vmcnt(5) lgkmcnt(4)
    v_mfma_f32_16x16x32_bf16 v[80:83], v[128:131], v[56:59], v[80:83]
    v_mfma_f32_16x16x32_bf16 v[84:87], v[132:135], v[56:59], v[84:87]
    v_mfma_f32_16x16x32_bf16 v[88:91], v[136:139], v[56:59], v[88:91]
    v_mfma_f32_16x16x32_bf16 v[92:95], v[140:143], v[56:59], v[92:95]
    ds_read_b128 v[128:131], v7 offset:20480
    ds_read_b128 v[132:135], v7 offset:21504
    ds_read_b128 v[136:139], v7 offset:22528
    ds_read_b128 v[140:143], v7 offset:23552
    s_waitcnt vmcnt(4) lgkmcnt(4)
    v_mfma_f32_16x16x32_bf16 v[80:83], v[144:147], v[60:63], v[80:83]
    v_mfma_f32_16x16x32_bf16 v[84:87], v[148:151], v[60:63], v[84:87]
    v_mfma_f32_16x16x32_bf16 v[88:91], v[152:155], v[60:63], v[88:91]
    v_mfma_f32_16x16x32_bf16 v[92:95], v[156:159], v[60:63], v[92:95]
    ds_read_b128 v[144:147], v7 offset:24576
    ds_read_b128 v[148:151], v7 offset:25600
    ds_read_b128 v[152:155], v7 offset:26624
    ds_read_b128 v[156:159], v7 offset:27648
    s_waitcnt vmcnt(3) lgkmcnt(4)
    v_mfma_f32_16x16x32_bf16 v[80:83], v[128:131], v[64:67], v[80:83]
    v_mfma_f32_16x16x32_bf16 v[84:87], v[132:135], v[64:67], v[84:87]
    v_mfma_f32_16x16x32_bf16 v[88:91], v[136:139], v[64:67], v[88:91]
    v_mfma_f32_16x16x32_bf16 v[92:95], v[140:143], v[64:67], v[92:95]
    ds_read_b128 v[128:131], v7 offset:28672
    ds_read_b128 v[132:135], v7 offset:29696
    ds_read_b128 v[136:139], v7 offset:30720
    ds_read_b128 v[140:143], v7 offset:31744
    s_waitcnt vmcnt(2) lgkmcnt(4)
    v_mfma_f32_16x16x32_bf16 v[80:83], v[144:147], v[68:71], v[80:83]
    v_mfma_f32_16x16x32_bf16 v[84:87], v[148:151], v[68:71], v[84:87]
    v_mfma_f32_16x16x32_bf16 v[88:91], v[152:155], v[68:71], v[88:91]
    v_mfma_f32_16x16x32_bf16 v[92:95], v[156:159], v[68:71], v[92:95]
    ds_read_b128 v[144:147], v7 offset:32768
    ds_read_b128 v[148:151], v7 offset:33792
    ds_read_b128 v[152:155], v7 offset:34816
    ds_read_b128 v[156:159], v7 offset:35840
    s_waitcnt vmcnt(1) lgkmcnt(4)
    v_mfma_f32_16x16x32_bf16 v[80:83], v[128:131], v[72:75], v[80:83]
    v_mfma_f32_16x16x32_bf16 v[84:87], v[132:135], v[72:75], v[84:87]
    v_mfma_f32_16x16x32_bf16 v[88:91], v[136:139], v[72:75], v[88:91]
    v_mfma_f32_16x16x32_bf16 v[92:95], v[140:143], v[72:75], v[92:95]
    s_waitcnt vmcnt(0) lgkmcnt(0)
    v_mfma_f32_16x16x32_bf16 v[80:83], v[144:147], v[76:79], v[80:83]
    v_mfma_f32_16x16x32_bf16 v[84:87], v[148:151], v[76:79], v[84:87]
    v_mfma_f32_16x16x32_bf16 v[88:91], v[152:155], v[76:79], v[88:91]
    v_mfma_f32_16x16x32_bf16 v[92:95], v[156:159], v[76:79], v[92:95]
    s_sub_u32 s27, s22, 4
    s_lshl_b32 s27, s27, 4
    s_add_u32 s37, s36, 9216
    v_and_b32 v2, 15, v0
    v_add_u32 v2, s27, v2
    v_mul_u32_u24 v3, 57, v2
    v_lshrrev_b32 v3, 10, v3
    v_mul_u32_u24 v4, 18, v3
    v_sub_u32 v2, v2, v4
    v_bfe_u32 v4, v0, 4, 1
    v_mad_u32_u24 v2, v4, 18, v2
    v_lshlrev_b32 v2, 4, v2
    v_mul_u32_u24 v3, 2304, v3
    v_lshrrev_b32 v4, 5, v0
    v_mul_u32_u24 v4, 576, v4
    v_add3_u32 v2, v2, v3, v4
    v_cvt_pk_bf16_f32 v128, v80, v81
    v_cvt_pk_bf16_f32 v130, v84, v85
    v_cvt_pk_bf16_f32 v129, v82, v83
    v_cvt_pk_bf16_f32 v131, v86, v87
    buffer_store_dwordx4 v[128:131], v2, s[4:7], s36 offen offset:1152 sc1
    v_cvt_pk_bf16_f32 v132, v88, v89
    v_cvt_pk_bf16_f32 v134, v92, v93
    v_cvt_pk_bf16_f32 v133, v90, v91
    v_cvt_pk_bf16_f32 v135, v94, v95
    buffer_store_dwordx4 v[132:135], v2, s[4:7], s37 offen offset:1152 sc1
    s_branch A_DONE
A_HALF:
    s_and_b32 s27, s22, 1
    s_lshl_b32 s27, s27, 11
    s_add_u32 s27, s27, 0
    v_add_u32 v6, s27, v1
    v_add_u32 v7, 36864, v6
    s_and_b32 s27, s22, 1
    s_mul_i32 s28, s27, 9216
    s_add_u32 s36, s36, s28
    s_cmp_ge_u32 s22, 10
    s_cbranch_scc1 A_EX
    ds_read_b128 v[128:131], v6 offset:0
    ds_read_b128 v[132:135], v6 offset:1024
    ds_read_b128 v[144:147], v6 offset:4096
    ds_read_b128 v[148:151], v6 offset:5120
    s_waitcnt vmcnt(17) lgkmcnt(2)
    v_mfma_f32_16x16x32_bf16 v[80:83], v[128:131], v[8:11], 0
    v_mfma_f32_16x16x32_bf16 v[84:87], v[132:135], v[8:11], 0
    ds_read_b128 v[128:131], v6 offset:8192
    ds_read_b128 v[132:135], v6 offset:9216
    s_waitcnt vmcnt(16) lgkmcnt(2)
    v_mfma_f32_16x16x32_bf16 v[80:83], v[144:147], v[12:15], v[80:83]
    v_mfma_f32_16x16x32_bf16 v[84:87], v[148:151], v[12:15], v[84:87]
    ds_read_b128 v[144:147], v6 offset:12288
    ds_read_b128 v[148:151], v6 offset:13312
    s_waitcnt vmcnt(15) lgkmcnt(2)
    v_mfma_f32_16x16x32_bf16 v[80:83], v[128:131], v[16:19], v[80:83]
    v_mfma_f32_16x16x32_bf16 v[84:87], v[132:135], v[16:19], v[84:87]
    ds_read_b128 v[128:131], v6 offset:16384
    ds_read_b128 v[132:135], v6 offset:17408
    s_waitcnt vmcnt(14) lgkmcnt(2)
    v_mfma_f32_16x16x32_bf16 v[80:83], v[144:147], v[20:23], v[80:83]
    v_mfma_f32_16x16x32_bf16 v[84:87], v[148:151], v[20:23], v[84:87]
    ds_read_b128 v[144:147], v6 offset:20480
    ds_read_b128 v[148:151], v6 offset:21504
    s_waitcnt vmcnt(13) lgkmcnt(2)
    v_mfma_f32_16x16x32_bf16 v[80:83], v[128:131], v[24:27], v[80:83]
    v_mfma_f32_16x16x32_bf16 v[84:87], v[132:135], v[24:27], v[84:87]
    ds_read_b128 v[128:131], v6 offset:24576
    ds_read_b128 v[132:135], v6 offset:25600
    s_waitcnt vmcnt(12) lgkmcnt(2)
    v_mfma_f32_16x16x32_bf16 v[80:83], v[144:147], v[28:31], v[80:83]
    v_mfma_f32_16x16x32_bf16 v[84:87], v[148:151], v[28:31], v[84:87]
    ds_read_b128 v[144:147], v6 offset:28672
    ds_read_b128 v[148:151], v6 offset:29696
    s_waitcnt vmcnt(11) lgkmcnt(2)
    v_mfma_f32_16x16x32_bf16 v[80:83], v[128:131], v[32:35], v[80:83]
    v_mfma_f32_16x16x32_bf16 v[84:87], v[132:135], v[32:35], v[84:87]
    ds_read_b128 v[128:131], v6 offset:32768
    ds_read_b128 v[132:135], v6 offset:33792
    s_waitcnt vmcnt(10) lgkmcnt(2)
    v_mfma_f32_16x16x32_bf16 v[80:83], v[144:147], v[36:39], v[80:83]
    v_mfma_f32_16x16x32_bf16 v[84:87], v[148:151], v[36:39], v[84:87]
    ds_read_b128 v[144:147], v7 offset:0
    ds_read_b128 v[148:151], v7 offset:1024
    s_waitcnt vmcnt(9) lgkmcnt(2)
    v_mfma_f32_16x16x32_bf16 v[80:83], v[128:131], v[40:43], v[80:83]
    v_mfma_f32_16x16x32_bf16 v[84:87], v[132:135], v[40:43], v[84:87]
    ds_read_b128 v[128:131], v7 offset:4096
    ds_read_b128 v[132:135], v7 offset:5120
    s_waitcnt vmcnt(8) lgkmcnt(2)
    v_mfma_f32_16x16x32_bf16 v[80:83], v[144:147], v[44:47], v[80:83]
    v_mfma_f32_16x16x32_bf16 v[84:87], v[148:151], v[44:47], v[84:87]
    ds_read_b128 v[144:147], v7 offset:8192
    ds_read_b128 v[148:151], v7 offset:9216
    s_waitcnt vmcnt(7) lgkmcnt(2)
    v_mfma_f32_16x16x32_bf16 v[80:83], v[128:131], v[48:51], v[80:83]
    v_mfma_f32_16x16x32_bf16 v[84:87], v[132:135], v[48:51], v[84:87]
    ds_read_b128 v[128:131], v7 offset:12288
    ds_read_b128 v[132:135], v7 offset:13312
    s_waitcnt vmcnt(6) lgkmcnt(2)
    v_mfma_f32_16x16x32_bf16 v[80:83], v[144:147], v[52:55], v[80:83]
    v_mfma_f32_16x16x32_bf16 v[84:87], v[148:151], v[52:55], v[84:87]
    ds_read_b128 v[144:147], v7 offset:16384
    ds_read_b128 v[148:151], v7 offset:17408
    s_waitcnt vmcnt(5) lgkmcnt(2)
    v_mfma_f32_16x16x32_bf16 v[80:83], v[128:131], v[56:59], v[80:83]
    v_mfma_f32_16x16x32_bf16 v[84:87], v[132:135], v[56:59], v[84:87]
    ds_read_b128 v[128:131], v7 offset:20480
    ds_read_b128 v[132:135], v7 offset:21504
    s_waitcnt vmcnt(4) lgkmcnt(2)
    v_mfma_f32_16x16x32_bf16 v[80:83], v[144:147], v[60:63], v[80:83]
    v_mfma_f32_16x16x32_bf16 v[84:87], v[148:151], v[60:63], v[84:87]
    ds_read_b128 v[144:147], v7 offset:24576
    ds_read_b128 v[148:151], v7 offset:25600
    s_waitcnt vmcnt(3) lgkmcnt(2)
    v_mfma_f32_16x16x32_bf16 v[80:83], v[128:131], v[64:67], v[80:83]
    v_mfma_f32_16x16x32_bf16 v[84:87], v[132:135], v[64:67], v[84:87]
    ds_read_b128 v[128:131], v7 offset:28672
    ds_read_b128 v[132:135], v7 offset:29696
    s_waitcnt vmcnt(2) lgkmcnt(2)
    v_mfma_f32_16x16x32_bf16 v[80:83], v[144:147], v[68:71], v[80:83]
    v_mfma_f32_16x16x32_bf16 v[84:87], v[148:151], v[68:71], v[84:87]
    ds_read_b128 v[144:147], v7 offset:32768
    ds_read_b128 v[148:151], v7 offset:33792
    s_waitcnt vmcnt(1) lgkmcnt(2)
    v_mfma_f32_16x16x32_bf16 v[80:83], v[128:131], v[72:75], v[80:83]
    v_mfma_f32_16x16x32_bf16 v[84:87], v[132:135], v[72:75], v[84:87]
    s_waitcnt vmcnt(0) lgkmcnt(0)
    v_mfma_f32_16x16x32_bf16 v[80:83], v[144:147], v[76:79], v[80:83]
    v_mfma_f32_16x16x32_bf16 v[84:87], v[148:151], v[76:79], v[84:87]
    v_and_b32 v2, 15, v0
    v_add_u32 v2, 64, v2
    v_mul_u32_u24 v3, 57, v2
    v_lshrrev_b32 v3, 10, v3
    v_mul_u32_u24 v4, 18, v3
    v_sub_u32 v2, v2, v4
    v_bfe_u32 v4, v0, 4, 1
    v_mad_u32_u24 v2, v4, 18, v2
    v_lshlrev_b32 v2, 4, v2
    v_mul_u32_u24 v3, 2304, v3
    v_lshrrev_b32 v4, 5, v0
    v_mul_u32_u24 v4, 576, v4
    v_add3_u32 v2, v2, v3, v4
    v_cvt_pk_bf16_f32 v128, v80, v81
    v_cvt_pk_bf16_f32 v130, v84, v85
    v_cvt_pk_bf16_f32 v129, v82, v83
    v_cvt_pk_bf16_f32 v131, v86, v87
    s_mov_b32 exec_lo, 0x00ff00ff
    s_mov_b32 exec_hi, 0x00ff00ff
    buffer_store_dwordx4 v[128:131], v2, s[4:7], s36 offen offset:1152 sc1
    s_mov_b64 exec, -1
    s_branch A_DONE
A_EX:
    ds_read_b128 v[128:131], v6 offset:0
    ds_read_b128 v[132:135], v6 offset:1024
    ds_read_b128 v[144:147], v6 offset:4096
    ds_read_b128 v[148:151], v6 offset:5120
    s_waitcnt vmcnt(17) lgkmcnt(2)
    v_mfma_f32_16x16x32_bf16 v[80:83], v[8:11], v[128:131], 0
    v_mfma_f32_16x16x32_bf16 v[84:87], v[8:11], v[132:135], 0
    ds_read_b128 v[128:131], v6 offset:8192
    ds_read_b128 v[132:135], v6 offset:9216
    s_waitcnt vmcnt(16) lgkmcnt(2)
    v_mfma_f32_16x16x32_bf16 v[80:83], v[12:15], v[144:147], v[80:83]
    v_mfma_f32_16x16x32_bf16 v[84:87], v[12:15], v[148:151], v[84:87]
    ds_read_b128 v[144:147], v6 offset:12288
    ds_read_b128 v[148:151], v6 offset:13312
    s_waitcnt vmcnt(15) lgkmcnt(2)
    v_mfma_f32_16x16x32_bf16 v[80:83], v[16:19], v[128:131], v[80:83]
    v_mfma_f32_16x16x32_bf16 v[84:87], v[16:19], v[132:135], v[84:87]
    ds_read_b128 v[128:131], v6 offset:16384
    ds_read_b128 v[132:135], v6 offset:17408
    s_waitcnt vmcnt(14) lgkmcnt(2)
    v_mfma_f32_16x16x32_bf16 v[80:83], v[20:23], v[144:147], v[80:83]
    v_mfma_f32_16x16x32_bf16 v[84:87], v[20:23], v[148:151], v[84:87]
    ds_read_b128 v[144:147], v6 offset:20480
    ds_read_b128 v[148:151], v6 offset:21504
    s_waitcnt vmcnt(13) lgkmcnt(2)
    v_mfma_f32_16x16x32_bf16 v[80:83], v[24:27], v[128:131], v[80:83]
    v_mfma_f32_16x16x32_bf16 v[84:87], v[24:27], v[132:135], v[84:87]
    ds_read_b128 v[128:131], v6 offset:24576
    ds_read_b128 v[132:135], v6 offset:25600
    s_waitcnt vmcnt(12) lgkmcnt(2)
    v_mfma_f32_16x16x32_bf16 v[80:83], v[28:31], v[144:147], v[80:83]
    v_mfma_f32_16x16x32_bf16 v[84:87], v[28:31], v[148:151], v[84:87]
    ds_read_b128 v[144:147], v6 offset:28672
    ds_read_b128 v[148:151], v6 offset:29696
    s_waitcnt vmcnt(11) lgkmcnt(2)
    v_mfma_f32_16x16x32_bf16 v[80:83], v[32:35], v[128:131], v[80:83]
    v_mfma_f32_16x16x32_bf16 v[84:87], v[32:35], v[132:135], v[84:87]
    ds_read_b128 v[128:131], v6 offset:32768
    ds_read_b128 v[132:135], v6 offset:33792
    s_waitcnt vmcnt(10) lgkmcnt(2)
    v_mfma_f32_16x16x32_bf16 v[80:83], v[36:39], v[144:147], v[80:83]
    v_mfma_f32_16x16x32_bf16 v[84:87], v[36:39], v[148:151], v[84:87]
    ds_read_b128 v[144:147], v7 offset:0
    ds_read_b128 v[148:151], v7 offset:1024
    s_waitcnt vmcnt(9) lgkmcnt(2)
    v_mfma_f32_16x16x32_bf16 v[80:83], v[40:43], v[128:131], v[80:83]
    v_mfma_f32_16x16x32_bf16 v[84:87], v[40:43], v[132:135], v[84:87]
    ds_read_b128 v[128:131], v7 offset:4096
    ds_read_b128 v[132:135], v7 offset:5120
    s_waitcnt vmcnt(8) lgkmcnt(2)
    v_mfma_f32_16x16x32_bf16 v[80:83], v[44:47], v[144:147], v[80:83]
    v_mfma_f32_16x16x32_bf16 v[84:87], v[44:47], v[148:151], v[84:87]
    ds_read_b128 v[144:147], v7 offset:8192
    ds_read_b128 v[148:151], v7 offset:9216
    s_waitcnt vmcnt(7) lgkmcnt(2)
    v_mfma_f32_16x16x32_bf16 v[80:83], v[48:51], v[128:131], v[80:83]
    v_mfma_f32_16x16x32_bf16 v[84:87], v[48:51], v[132:135], v[84:87]
    ds_read_b128 v[128:131], v7 offset:12288
    ds_read_b128 v[132:135], v7 offset:13312
    s_waitcnt vmcnt(6) lgkmcnt(2)
    v_mfma_f32_16x16x32_bf16 v[80:83], v[52:55], v[144:147], v[80:83]
    v_mfma_f32_16x16x32_bf16 v[84:87], v[52:55], v[148:151], v[84:87]
    ds_read_b128 v[144:147], v7 offset:16384
    ds_read_b128 v[148:151], v7 offset:17408
    s_waitcnt vmcnt(5) lgkmcnt(2)
    v_mfma_f32_16x16x32_bf16 v[80:83], v[56:59], v[128:131], v[80:83]
    v_mfma_f32_16x16x32_bf16 v[84:87], v[56:59], v[132:135], v[84:87]
    ds_read_b128 v[128:131], v7 offset:20480
    ds_read_b128 v[132:135], v7 offset:21504
    s_waitcnt vmcnt(4) lgkmcnt(2)
    v_mfma_f32_16x16x32_bf16 v[80:83], v[60:63], v[144:147], v[80:83]
    v_mfma_f32_16x16x32_bf16 v[84:87], v[60:63], v[148:151], v[84:87]
    ds_read_b128 v[144:147], v7 offset:24576
    ds_read_b128 v[148:151], v7 offset:25600
    s_waitcnt vmcnt(3) lgkmcnt(2)
    v_mfma_f32_16x16x32_bf16 v[80:83], v[64:67], v[128:131], v[80:83]
    v_mfma_f32_16x16x32_bf16 v[84:87], v[64:67], v[132:135], v[84:87]
    ds_read_b128 v[128:131], v7 offset:28672
    ds_read_b128 v[132:135], v7 offset:29696
    s_waitcnt vmcnt(2) lgkmcnt(2)
    v_mfma_f32_16x16x32_bf16 v[80:83], v[68:71], v[144:147], v[80:83]
    v_mfma_f32_16x16x32_bf16 v[84:87], v[68:71], v[148:151], v[84:87]
    ds_read_b128 v[144:147], v7 offset:32768
    ds_read_b128 v[148:151], v7 offset:33792
    s_waitcnt vmcnt(1) lgkmcnt(2)
    v_mfma_f32_16x16x32_bf16 v[80:83], v[72:75], v[128:131], v[80:83]
    v_mfma_f32_16x16x32_bf16 v[84:87], v[72:75], v[132:135], v[84:87]
    s_waitcnt vmcnt(0) lgkmcnt(0)
    v_mfma_f32_16x16x32_bf16 v[80:83], v[76:79], v[144:147], v[80:83]
    v_mfma_f32_16x16x32_bf16 v[84:87], v[76:79], v[148:151], v[84:87]
    v_lshrrev_b32 v4, 4, v0
    v_mul_u32_u24 v2, 2304, v4
    v_bfe_u32 v3, v0, 3, 1
    v_lshl_add_u32 v2, v3, 6, v2
    v_and_b32 v3, 7, v0
    v_lshl_add_u32 v2, v3, 2, v2
    v_and_b32 v3, 15, v0
    v_lshlrev_b32 v3, 2, v3
    v_lshl_add_u32 v3, v4, 8, v3
    s_and_b32 s27, s22, 1
    s_lshl_b32 s27, s27, 7
    s_add_u32 s27, s27, 81920
    v_add_u32 v3, s27, v3
    v_mul_f32 v82, s60, v82
    v_mul_f32 v83, s60, v83
    v_cvt_pk_bf16_f32 v128, v80, v81
    v_cvt_pk_bf16_f32 v129, v82, v83
    buffer_store_dword v128, v2, s[4:7], s36 offen offset:1024 sc1
    ds_write_b32 v3, v129 offset:0
    v_mul_f32 v86, s60, v86
    v_mul_f32 v87, s60, v87
    v_cvt_pk_bf16_f32 v130, v84, v85
    v_cvt_pk_bf16_f32 v131, v86, v87
    buffer_store_dword v130, v2, s[4:7], s36 offen offset:1056 sc1
    ds_write_b32 v3, v131 offset:64
A_DONE:
    s_waitcnt vmcnt(0) lgkmcnt(0)
    s_barrier
    s_cmp_lg_u32 s22, 4
    s_cbranch_scc1 Lf8
    s_add_u32 s27, s24, 1
    s_lshl_b32 s28, s20, 8
    s_lshl_b32 s29, s21, 2
    s_add_u32 s28, s28, s29
    v_mov_b32 v2, s27
    v_mov_b32 v3, 0
    s_mov_b64 exec, 1
    buffer_store_dword v2, v3, s[4:7], s28 offen sc1
    s_mov_b64 exec, -1
Lf8:
    s_cmp_ge_u32 s22, 4
    s_cbranch_scc1 A_NQ
    ds_read_b128 v[128:131], v6 offset:0
    ds_read_b128 v[132:135], v6 offset:1024
    ds_read_b128 v[136:139], v6 offset:2048
    ds_read_b128 v[140:143], v6 offset:3072
    ds_read_b128 v[144:147], v6 offset:4096
    ds_read_b128 v[148:151], v6 offset:5120
    ds_read_b128 v[152:155], v6 offset:6144
    ds_read_b128 v[156:159], v6 offset:7168
    s_waitcnt lgkmcnt(4)
    v_mfma_f32_16x16x32_bf16 v[80:83], v[8:11], v[128:131], 0
    v_mfma_f32_16x16x32_bf16 v[84:87], v[8:11], v[132:135], 0
    v_mfma_f32_16x16x32_bf16 v[88:91], v[8:11], v[136:139], 0
    v_mfma_f32_16x16x32_bf16 v[92:95], v[8:11], v[140:143], 0
    ds_read_b128 v[128:131], v6 offset:8192
    ds_read_b128 v[132:135], v6 offset:9216
    ds_read_b128 v[136:139], v6 offset:10240
    ds_read_b128 v[140:143], v6 offset:11264
    s_waitcnt lgkmcnt(4)
    v_mfma_f32_16x16x32_bf16 v[80:83], v[12:15], v[144:147], v[80:83]
    v_mfma_f32_16x16x32_bf16 v[84:87], v[12:15], v[148:151], v[84:87]
    v_mfma_f32_16x16x32_bf16 v[88:91], v[12:15], v[152:155], v[88:91]
    v_mfma_f32_16x16x32_bf16 v[92:95], v[12:15], v[156:159], v[92:95]
    ds_read_b128 v[144:147], v6 offset:12288
    ds_read_b128 v[148:151], v6 offset:13312
    ds_read_b128 v[152:155], v6 offset:14336
    ds_read_b128 v[156:159], v6 offset:15360
    s_waitcnt lgkmcnt(4)
    v_mfma_f32_16x16x32_bf16 v[80:83], v[16:19], v[128:131], v[80:83]
    v_mfma_f32_16x16x32_bf16 v[84:87], v[16:19], v[132:135], v[84:87]
    v_mfma_f32_16x16x32_bf16 v[88:91], v[16:19], v[136:139], v[88:91]
    v_mfma_f32_16x16x32_bf16 v[92:95], v[16:19], v[140:143], v[92:95]
    ds_read_b128 v[128:131], v6 offset:16384
    ds_read_b128 v[132:135], v6 offset:17408
    ds_read_b128 v[136:139], v6 offset:18432
    ds_read_b128 v[140:143], v6 offset:19456
    s_waitcnt lgkmcnt(4)
    v_mfma_f32_16x16x32_bf16 v[80:83], v[20:23], v[144:147], v[80:83]
    v_mfma_f32_16x16x32_bf16 v[84:87], v[20:23], v[148:151], v[84:87]
    v_mfma_f32_16x16x32_bf16 v[88:91], v[20:23], v[152:155], v[88:91]
    v_mfma_f32_16x16x32_bf16 v[92:95], v[20:23], v[156:159], v[92:95]
    ds_read_b128 v[144:147], v6 offset:20480
    ds_read_b128 v[148:151], v6 offset:21504
    ds_read_b128 v[152:155], v6 offset:22528
    ds_read_b128 v[156:159], v6 offset:23552
    s_waitcnt lgkmcnt(4)
    v_mfma_f32_16x16x32_bf16 v[80:83], v[24:27], v[128:131], v[80:83]
    v_mfma_f32_16x16x32_bf16 v[84:87], v[24:27], v[132:135], v[84:87]
    v_mfma_f32_16x16x32_bf16 v[88:91], v[24:27], v[136:139], v[88:91]
    v_mfma_f32_16x16x32_bf16 v[92:95], v[24:27], v[140:143], v[92:95]
    ds_read_b128 v[128:131], v6 offset:24576
    ds_read_b128 v[132:135], v6 offset:25600
    ds_read_b128 v[136:139], v6 offset:26624
    ds_read_b128 v[140:143], v6 offset:27648
    s_waitcnt lgkmcnt(4)
    v_mfma_f32_16x16x32_bf16 v[80:83], v[28:31], v[144:147], v[80:83]
    v_mfma_f32_16x16x32_bf16 v[84:87], v[28:31], v[148:151], v[84:87]
    v_mfma_f32_16x16x32_bf16 v[88:91], v[28:31], v[152:155], v[88:91]
    v_mfma_f32_16x16x32_bf16 v[92:95], v[28:31], v[156:159], v[92:95]
    ds_read_b128 v[144:147], v6 offset:28672
    ds_read_b128 v[148:151], v6 offset:29696
    ds_read_b128 v[152:155], v6 offset:30720
    ds_read_b128 v[156:159], v6 offset:31744
    s_waitcnt lgkmcnt(4)
    v_mfma_f32_16x16x32_bf16 v[80:83], v[32:35], v[128:131], v[80:83]
    v_mfma_f32_16x16x32_bf16 v[84:87], v[32:35], v[132:135], v[84:87]
    v_mfma_f32_16x16x32_bf16 v[88:91], v[32:35], v[136:139], v[88:91]
    v_mfma_f32_16x16x32_bf16 v[92:95], v[32:35], v[140:143], v[92:95]
    ds_read_b128 v[128:131], v6 offset:32768
    ds_read_b128 v[132:135], v6 offset:33792
    ds_read_b128 v[136:139], v6 offset:34816
    ds_read_b128 v[140:143], v6 offset:35840
    s_waitcnt lgkmcnt(4)
    v_mfma_f32_16x16x32_bf16 v[80:83], v[36:39], v[144:147], v[80:83]
    v_mfma_f32_16x16x32_bf16 v[84:87], v[36:39], v[148:151], v[84:87]
    v_mfma_f32_16x16x32_bf16 v[88:91], v[36:39], v[152:155], v[88:91]
    v_mfma_f32_16x16x32_bf16 v[92:95], v[36:39], v[156:159], v[92:95]
    ds_read_b128 v[144:147], v7 offset:0
    ds_read_b128 v[148:151], v7 offset:1024
    ds_read_b128 v[152:155], v7 offset:2048
    ds_read_b128 v[156:159], v7 offset:3072
    s_waitcnt lgkmcnt(4)
    v_mfma_f32_16x16x32_bf16 v[80:83], v[40:43], v[128:131], v[80:83]
    v_mfma_f32_16x16x32_bf16 v[84:87], v[40:43], v[132:135], v[84:87]
    v_mfma_f32_16x16x32_bf16 v[88:91], v[40:43], v[136:139], v[88:91]
    v_mfma_f32_16x16x32_bf16 v[92:95], v[40:43], v[140:143], v[92:95]
    ds_read_b128 v[128:131], v7 offset:4096
    ds_read_b128 v[132:135], v7 offset:5120
    ds_read_b128 v[136:139], v7 offset:6144
    ds_read_b128 v[140:143], v7 offset:7168
    s_waitcnt lgkmcnt(4)
    v_mfma_f32_16x16x32_bf16 v[80:83], v[44:47], v[144:147], v[80:83]
    v_mfma_f32_16x16x32_bf16 v[84:87], v[44:47], v[148:151], v[84:87]
    v_mfma_f32_16x16x32_bf16 v[88:91], v[44:47], v[152:155], v[88:91]
    v_mfma_f32_16x16x32_bf16 v[92:95], v[44:47], v[156:159], v[92:95]
    ds_read_b128 v[144:147], v7 offset:8192
    ds_read_b128 v[148:151], v7 offset:9216
    ds_read_b128 v[152:155], v7 offset:10240
    ds_read_b128 v[156:159], v7 offset:11264
    s_waitcnt lgkmcnt(4)
    v_mfma_f32_16x16x32_bf16 v[80:83], v[48:51], v[128:131], v[80:83]
    v_mfma_f32_16x16x32_bf16 v[84:87], v[48:51], v[132:135], v[84:87]
    v_mfma_f32_16x16x32_bf16 v[88:91], v[48:51], v[136:139], v[88:91]
    v_mfma_f32_16x16x32_bf16 v[92:95], v[48:51], v[140:143], v[92:95]
    ds_read_b128 v[128:131], v7 offset:12288
    ds_read_b128 v[132:135], v7 offset:13312
    ds_read_b128 v[136:139], v7 offset:14336
    ds_read_b128 v[140:143], v7 offset:15360
    s_waitcnt lgkmcnt(4)
    v_mfma_f32_16x16x32_bf16 v[80:83], v[52:55], v[144:147], v[80:83]
    v_mfma_f32_16x16x32_bf16 v[84:87], v[52:55], v[148:151], v[84:87]
    v_mfma_f32_16x16x32_bf16 v[88:91], v[52:55], v[152:155], v[88:91]
    v_mfma_f32_16x16x32_bf16 v[92:95], v[52:55], v[156:159], v[92:95]
    ds_read_b128 v[144:147], v7 offset:16384
    ds_read_b128 v[148:151], v7 offset:17408
    ds_read_b128 v[152:155], v7 offset:18432
    ds_read_b128 v[156:159], v7 offset:19456
    s_waitcnt lgkmcnt(4)
    v_mfma_f32_16x16x32_bf16 v[80:83], v[56:59], v[128:131], v[80:83]
    v_mfma_f32_16x16x32_bf16 v[84:87], v[56:59], v[132:135], v[84:87]
    v_mfma_f32_16x16x32_bf16 v[88:91], v[56:59], v[136:139], v[88:91]
    v_mfma_f32_16x16x32_bf16 v[92:95], v[56:59], v[140:143], v[92:95]
    ds_read_b128 v[128:131], v7 offset:20480
    ds_read_b128 v[132:135], v7 offset:21504
    ds_read_b128 v[136:139], v7 offset:22528
    ds_read_b128 v[140:143], v7 offset:23552
    s_waitcnt lgkmcnt(4)
    v_mfma_f32_16x16x32_bf16 v[80:83], v[60:63], v[144:147], v[80:83]
    v_mfma_f32_16x16x32_bf16 v[84:87], v[60:63], v[148:151], v[84:87]
    v_mfma_f32_16x16x32_bf16 v[88:91], v[60:63], v[152:155], v[88:91]
    v_mfma_f32_16x16x32_bf16 v[92:95], v[60:63], v[156:159], v[92:95]
    ds_read_b128 v[144:147], v7 offset:24576
    ds_read_b128 v[148:151], v7 offset:25600
    ds_read_b128 v[152:155], v7 offset:26624
    ds_read_b128 v[156:159], v7 offset:27648
    s_waitcnt lgkmcnt(4)
    v_mfma_f32_16x16x32_bf16 v[80:83], v[64:67], v[128:131], v[80:83]
    v_mfma_f32_16x16x32_bf16 v[84:87], v[64:67], v[132:135], v[84:87]
    v_mfma_f32_16x16x32_bf16 v[88:91], v[64:67], v[136:139], v[88:91]
    v_mfma_f32_16x16x32_bf16 v[92:95], v[64:67], v[140:143], v[92:95]
    ds_read_b128 v[128:131], v7 offset:28672
    ds_read_b128 v[132:135], v7 offset:29696
    ds_read_b128 v[136:139], v7 offset:30720
    ds_read_b128 v[140:143], v7 offset:31744
    s_waitcnt lgkmcnt(4)
    v_mfma_f32_16x16x32_bf16 v[80:83], v[68:71], v[144:147], v[80:83]
    v_mfma_f32_16x16x32_bf16 v[84:87], v[68:71], v[148:151], v[84:87]
    v_mfma_f32_16x16x32_bf16 v[88:91], v[68:71], v[152:155], v[88:91]
    v_mfma_f32_16x16x32_bf16 v[92:95], v[68:71], v[156:159], v[92:95]
    ds_read_b128 v[144:147], v7 offset:32768
    ds_read_b128 v[148:151], v7 offset:33792
    ds_read_b128 v[152:155], v7 offset:34816
    ds_read_b128 v[156:159], v7 offset:35840
    s_waitcnt lgkmcnt(4)
    v_mfma_f32_16x16x32_bf16 v[80:83], v[72:75], v[128:131], v[80:83]
    v_mfma_f32_16x16x32_bf16 v[84:87], v[72:75], v[132:135], v[84:87]
    v_mfma_f32_16x16x32_bf16 v[88:91], v[72:75], v[136:139], v[88:91]
    v_mfma_f32_16x16x32_bf16 v[92:95], v[72:75], v[140:143], v[92:95]
    s_waitcnt lgkmcnt(0)
    v_mfma_f32_16x16x32_bf16 v[80:83], v[76:79], v[144:147], v[80:83]
    v_mfma_f32_16x16x32_bf16 v[84:87], v[76:79], v[148:151], v[84:87]
    v_mfma_f32_16x16x32_bf16 v[88:91], v[76:79], v[152:155], v[88:91]
    v_mfma_f32_16x16x32_bf16 v[92:95], v[76:79], v[156:159], v[92:95]
    s_lshl_b32 s27, s22, 11
    s_add_u32 s27, s27, 73728
    v_add_u32 v3, s27, v1
    s_nop 1
    v_mul_f32 v80, s60, v80
    v_mul_f32 v81, s60, v81
    v_mul_f32 v82, s60, v82
    v_mul_f32 v83, s60, v83
    v_mul_f32 v84, s60, v84
    v_mul_f32 v85, s60, v85
    v_mul_f32 v86, s60, v86
    v_mul_f32 v87, s60, v87
    v_mul_f32 v88, s60, v88
    v_mul_f32 v89, s60, v89
    v_mul_f32 v90, s60, v90
    v_mul_f32 v91, s60, v91
    v_mul_f32 v92, s60, v92
    v_mul_f32 v93, s60, v93
    v_mul_f32 v94, s60, v94
    v_mul_f32 v95, s60, v95
    v_cvt_pk_bf16_f32 v136, v80, v81
    v_cvt_pk_bf16_f32 v138, v84, v85
    v_cvt_pk_bf16_f32 v137, v82, v83
    v_cvt_pk_bf16_f32 v139, v86, v87
    v_permlane16_swap_b32 v136, v138
    s_nop 0
    v_permlane16_swap_b32 v137, v139
    ds_write_b128 v3, v[136:139] offset:0
    v_cvt_pk_bf16_f32 v140, v88, v89
    v_cvt_pk_bf16_f32 v142, v92, v93
    v_cvt_pk_bf16_f32 v141, v90, v91
    v_cvt_pk_bf16_f32 v143, v94, v95
    v_permlane16_swap_b32 v140, v142
    s_nop 0
    v_permlane16_swap_b32 v141, v143
    ds_write_b128 v3, v[140:143] offset:1024
    s_waitcnt lgkmcnt(0)
A_NQ:
    s_cmp_lg_u32 s23, 0
    s_cbranch_scc1 B_NL
    s_cmp_lt_u32 s22, 8
    s_cbranch_scc1 B_NL
    s_cmp_lt_u32 s20, 16
    s_cselect_b32 s27, 32, 48
    s_load_dwordx2 s[8:9], s[0:1], s27
    s_mov_b32 s10, 5308416
    s_movk_i32 s30, 1152
    s_cselect_b32 s28, 9216, s30
    s_cselect_b32 s29, s30, 663552
    s_mul_i32 s29, s29, s21
    s_and_b32 s30, s20, 3
    s_mul_i32 s30, s30, 288
    s_add_u32 s29, s29, s30
    s_bfe_u32 s30, s20, 0x20002
    s_mul_i32 s30, s30, 18
    s_and_b32 s31, s22, 3
    s_mul_i32 s31, s31, 9
    s_lshr_b32 s31, s31, 1
    s_add_u32 s62, s30, s31
    s_lshl_b32 s30, s62, 3
    s_mul_i32 s30, s30, s28
    s_add_u32 s29, s29, s30
    s_waitcnt lgkmcnt(0)
    v_add_u32 v2, 0, v0
    v_mul_u32_u24 v3, 3641, v2
    v_lshrrev_b32 v3, 16, v3
    v_mul_u32_u24 v4, 18, v3
    v_sub_u32 v4, v2, v4
    v_lshlrev_b32 v4, 4, v4
    v_mad_u32_u24 v4, v3, s28, v4
    buffer_load_dwordx4 v[16:19], v4, s[8:11], s29 offen
    v_add_u32 v2, 64, v0
    v_mul_u32_u24 v3, 3641, v2
    v_lshrrev_b32 v3, 16, v3
    v_mul_u32_u24 v4, 18, v3
    v_sub_u32 v4, v2, v4
    v_lshlrev_b32 v4, 4, v4
    v_mad_u32_u24 v4, v3, s28, v4
    buffer_load_dwordx4 v[20:23], v4, s[8:11], s29 offen
    v_add_u32 v2, 128, v0
    v_mul_u32_u24 v3, 3641, v2
    v_lshrrev_b32 v3, 16, v3
    v_mul_u32_u24 v4, 18, v3
    v_sub_u32 v4, v2, v4
    v_lshlrev_b32 v4, 4, v4
    v_mad_u32_u24 v4, v3, s28, v4
    buffer_load_dwordx4 v[24:27], v4, s[8:11], s29 offen
    v_add_u32 v2, 192, v0
    v_mul_u32_u24 v3, 3641, v2
    v_lshrrev_b32 v3, 16, v3
    v_mul_u32_u24 v4, 18, v3
    v_sub_u32 v4, v2, v4
    v_lshlrev_b32 v4, 4, v4
    v_mad_u32_u24 v4, v3, s28, v4
    buffer_load_dwordx4 v[28:31], v4, s[8:11], s29 offen
    v_add_u32 v2, 256, v0
    v_mul_u32_u24 v3, 3641, v2
    v_lshrrev_b32 v3, 16, v3
    v_mul_u32_u24 v4, 18, v3
    v_sub_u32 v4, v2, v4
    v_lshlrev_b32 v4, 4, v4
    v_mad_u32_u24 v4, v3, s28, v4
    buffer_load_dwordx4 v[32:35], v4, s[8:11], s29 offen
    v_add_u32 v2, 320, v0
    v_mul_u32_u24 v3, 3641, v2
    v_lshrrev_b32 v3, 16, v3
    v_mul_u32_u24 v4, 18, v3
    v_sub_u32 v4, v2, v4
    v_lshlrev_b32 v4, 4, v4
    v_mad_u32_u24 v4, v3, s28, v4
    buffer_load_dwordx4 v[36:39], v4, s[8:11], s29 offen
    v_add_u32 v2, 384, v0
    v_mul_u32_u24 v3, 3641, v2
    v_lshrrev_b32 v3, 16, v3
    v_mul_u32_u24 v4, 18, v3
    v_sub_u32 v4, v2, v4
    v_lshlrev_b32 v4, 4, v4
    v_mad_u32_u24 v4, v3, s28, v4
    buffer_load_dwordx4 v[40:43], v4, s[8:11], s29 offen
    v_add_u32 v2, 448, v0
    v_mul_u32_u24 v3, 3641, v2
    v_lshrrev_b32 v3, 16, v3
    v_mul_u32_u24 v4, 18, v3
    v_sub_u32 v4, v2, v4
    v_lshlrev_b32 v4, 4, v4
    v_mad_u32_u24 v4, v3, s28, v4
    buffer_load_dwordx4 v[44:47], v4, s[8:11], s29 offen
    v_add_u32 v2, 512, v0
    v_mul_u32_u24 v3, 3641, v2
    v_lshrrev_b32 v3, 16, v3
    v_mul_u32_u24 v4, 18, v3
    v_sub_u32 v4, v2, v4
    v_lshlrev_b32 v4, 4, v4
    v_mad_u32_u24 v4, v3, s28, v4
    buffer_load_dwordx4 v[48:51], v4, s[8:11], s29 offen
    v_add_u32 v2, 576, v0
    v_mul_u32_u24 v3, 3641, v2
    v_lshrrev_b32 v3, 16, v3
    v_mul_u32_u24 v4, 18, v3
    v_sub_u32 v4, v2, v4
    v_lshlrev_b32 v4, 4, v4
    v_mad_u32_u24 v4, v3, s28, v4
    buffer_load_dwordx4 v[52:55], v4, s[8:11], s29 offen
    v_add_u32 v2, 640, v0
    v_mul_u32_u24 v3, 3641, v2
    v_lshrrev_b32 v3, 16, v3
    v_mul_u32_u24 v4, 18, v3
    v_sub_u32 v4, v2, v4
    v_lshlrev_b32 v4, 4, v4
    v_mad_u32_u24 v4, v3, s28, v4
    buffer_load_dwordx4 v[56:59], v4, s[8:11], s29 offen
    v_add_u32 v2, 704, v0
    v_mul_u32_u24 v3, 3641, v2
    v_lshrrev_b32 v3, 16, v3
    v_mul_u32_u24 v4, 18, v3
    v_sub_u32 v4, v2, v4
    v_lshlrev_b32 v4, 4, v4
    v_mad_u32_u24 v4, v3, s28, v4
    s_mov_b64 exec, 0xffff
    buffer_load_dwordx4 v[60:63], v4, s[8:11], s29 offen
    s_mov_b64 exec, -1
B_NL:
    v_and_b32 v2, 31, v0
    v_lshlrev_b32 v2, 2, v2
    s_mov_b32 vcc_lo, 0x00220000
    s_mov_b32 vcc_hi, 0x00220000
    v_mov_b32 v4, 0x3f803f80
    v_cndmask_b32 v4, 0, v4, vcc
    v_mov_b32 v116, v4
    v_mov_b32 v117, v4
    v_mov_b32 v118, v4
    v_mov_b32 v119, v4
    v_mov_b32 v120, v4
    v_mov_b32 v121, v4
    v_mov_b32 v122, v4
    v_mov_b32 v123, v4
    v_mov_b32 v124, v4
    v_mov_b32 v125, v4
    v_mov_b32 v126, v4
    v_mov_b32 v127, v4
    v_mov_b32 v128, v4
    v_mov_b32 v129, v4
    v_mov_b32 v130, v4
    v_mov_b32 v131, v4
    v_mov_b32 v132, v4
    v_mov_b32 v133, v4
    v_mov_b32 v134, v4
    v_mov_b32 v135, v4
    v_mov_b32 v136, v4
    v_mov_b32 v137, v4
    v_mov_b32 v138, v4
    v_mov_b32 v139, v4
    v_mov_b32 v140, v4
    v_mov_b32 v141, v4
    v_mov_b32 v142, v4
    v_mov_b32 v143, v4
    v_mov_b32 v144, v4
    v_mov_b32 v145, v4
    v_mov_b32 v146, v4
    v_mov_b32 v147, v4
    v_mov_b32 v148, v4
    v_mov_b32 v149, v4
    v_mov_b32 v150, v4
    v_mov_b32 v151, v4
    v_mov_b32 v152, v4
    v_mov_b32 v153, v4
    v_mov_b32 v154, v4
    v_mov_b32 v155, v4
    v_mov_b32 v156, v4
    v_mov_b32 v157, v4
    v_mov_b32 v158, v4
    v_mov_b32 v159, v4
    v_mov_b32 v160, v4
    v_mov_b32 v161, v4
    v_mov_b32 v162, v4
    v_mov_b32 v163, v4
    v_cmp_gt_u32 vcc, 32, v0
    v_mov_b32 v4, 0x3f803f80
    s_nop 0
    v_cndmask_b32 v4, 0, v4, vcc
    v_mov_b32 v80, v4
    v_mov_b32 v86, v4
    v_mov_b32 v92, v4
    v_mov_b32 v98, v4
    v_mov_b32 v104, v4
    v_mov_b32 v110, v4
    v_mov_b32 v13, 0
    v_mov_b32 v14, 0
    v_mov_b32 v15, 0
    v_mov_b32 v166, 0xf149f2ca
    v_and_b32 v3, 3, v0
    v_bfe_u32 v4, v0, 3, 2
    v_lshl_add_u32 v3, v4, 2, v3
    v_bfe_u32 v4, v0, 2, 1
    v_mad_u32_u24 v3, v4, 9, v3
    v_lshrrev_b32 v4, 5, v0
    v_mad_u32_u24 v3, v4, 18, v3
    v_lshlrev_b32 v3, 4, v3
    s_and_b32 s37, s22, 3
    s_bfe_u32 s38, s22, 0x10002
    s_lshl_b32 s39, s37, 1
    s_add_u32 s39, s39, s38
    s_lshl_b32 s39, s39, 10
    s_add_u32 s39, s39, 73728
    v_add_u32 v10, s39, v1
    s_lshl_b32 s39, s37, 8
    s_lshl_b32 s96, s38, 7
    s_add_u32 s39, s39, s96
    s_add_u32 s39, s39, 81920
    v_add_u32 v12, s39, v2
    v_mov_b32 v6, v2
    v_mov_b32 v7, v3
    s_cmp_lg_u32 s22, 4
    s_cbranch_scc1 Lp9
    s_cmp_lg_u32 s25, 0
    s_cbranch_scc1 Lp9
    s_cmp_eq_u32 s20, 0
    s_cbranch_scc1 Lp9
    s_min_u32 s29, s20, 4
    s_lshl_b32 s29, 1, s29
    s_sub_u32 s30, s29, 1
    s_mov_b32 s31, 0
    s_sub_u32 s28, s20, 1
    v_sub_u32 v2, s28, v0
    v_lshlrev_b32 v2, 8, v2
    s_lshl_b32 s28, s21, 2
    s_add_u32 s27, s24, 1
    s_mov_b32 s29, 400000
    s_mov_b64 exec, s[30:31]
Lpl10:
    buffer_load_dword v3, v2, s[4:7], s28 offen sc1
    s_waitcnt vmcnt(0)
    v_cmp_gt_u32 vcc, s27, v3
    s_nop 1
    s_cbranch_vccz Lpd11
    s_sub_u32 s29, s29, 1
    s_cbranch_scc0 Lpl10
    s_mov_b32 s25, 1
Lpd11:
    s_mov_b64 exec, -1
Lp9:
    s_barrier
    s_cmp_ge_u32 s22, 8
    s_cbranch_scc1 B_PREP
    s_lshl_b32 s36, s20, 1
    s_add_u32 s36, s36, s38
    s_sub_u32 s36, s36, 8
    s_mul_i32 s39, s21, 589824
    s_mul_i32 s96, s23, 4718592
    s_add_u32 s39, s39, s96
    s_mul_i32 s96, s37, 2304
    s_add_u32 s39, s39, s96
    s_add_u32 s39, s39, 14467072
    s_add_i32 s96, s36, 8
    s_max_i32 s96, s96, 0
    s_mul_i32 s96, s96, 9216
    s_add_u32 s35, s39, s96
    s_add_i32 s96, s36, 7
    s_max_i32 s96, s96, 0
    s_mul_i32 s96, s96, 9216
    s_add_u32 s34, s39, s96
    s_add_i32 s96, s36, 6
    s_max_i32 s96, s96, 0
    s_mul_i32 s96, s96, 9216
    s_add_u32 s33, s39, s96
    s_add_i32 s96, s36, 5
    s_max_i32 s96, s96, 0
    s_mul_i32 s96, s96, 9216
    s_add_u32 s32, s39, s96
    s_add_i32 s96, s36, 4
    s_max_i32 s96, s96, 0
    s_mul_i32 s96, s96, 9216
    s_add_u32 s31, s39, s96
    s_add_i32 s96, s36, 3
    s_max_i32 s96, s96, 0
    s_mul_i32 s96, s96, 9216
    s_add_u32 s30, s39, s96
    s_add_i32 s96, s36, 2
    s_max_i32 s96, s96, 0
    s_mul_i32 s96, s96, 9216
    s_add_u32 s29, s39, s96
    s_add_i32 s96, s36, 1
    s_max_i32 s96, s96, 0
    s_mul_i32 s96, s96, 9216
    s_add_u32 s28, s39, s96
    s_add_i32 s96, s36, 0
    s_max_i32 s96, s96, 0
    s_mul_i32 s96, s96, 9216
    s_add_u32 s27, s39, s96
    buffer_load_dwordx4 v[82:85], v1, s[4:7], s33 offen sc1
    buffer_load_dword v81, v6, s[4:7], s33 offen offset:1024 sc1
    buffer_load_dwordx4 v[88:91], v1, s[4:7], s34 offen sc1
    buffer_load_dword v87, v6, s[4:7], s34 offen offset:1024 sc1
    buffer_load_dwordx4 v[94:97], v1, s[4:7], s35 offen sc1
    buffer_load_dword v93, v6, s[4:7], s35 offen offset:1024 sc1
    s_mov_b32 exec_lo, 0x0011ffff
    s_mov_b32 exec_hi, 0x0011ffff
    buffer_load_dwordx4 v[116:119], v7, s[4:7], s33 offen offset:1152 sc1
    buffer_load_dwordx4 v[120:123], v7, s[4:7], s33 offen offset:1728 sc1
    buffer_load_dwordx4 v[124:127], v7, s[4:7], s34 offen offset:1152 sc1
    buffer_load_dwordx4 v[128:131], v7, s[4:7], s34 offen offset:1728 sc1
    buffer_load_dwordx4 v[132:135], v7, s[4:7], s35 offen offset:1152 sc1
    buffer_load_dwordx4 v[136:139], v7, s[4:7], s35 offen offset:1728 sc1
    s_mov_b64 exec, -1
B_W1:
    buffer_load_dwordx4 v[100:103], v1, s[4:7], s30 offen sc1
    buffer_load_dword v99, v6, s[4:7], s30 offen offset:1024 sc1
    buffer_load_dwordx4 v[106:109], v1, s[4:7], s31 offen sc1
    buffer_load_dword v105, v6, s[4:7], s31 offen offset:1024 sc1
    buffer_load_dwordx4 v[112:115], v1, s[4:7], s32 offen sc1
    buffer_load_dword v111, v6, s[4:7], s32 offen offset:1024 sc1
    s_mov_b32 exec_lo, 0x0011ffff
    s_mov_b32 exec_hi, 0x0011ffff
    buffer_load_dwordx4 v[140:143], v7, s[4:7], s30 offen offset:1152 sc1
    buffer_load_dwordx4 v[144:147], v7, s[4:7], s30 offen offset:1728 sc1
    buffer_load_dwordx4 v[148:151], v7, s[4:7], s31 offen offset:1152 sc1
    buffer_load_dwordx4 v[152:155], v7, s[4:7], s31 offen offset:1728 sc1
    buffer_load_dwordx4 v[156:159], v7, s[4:7], s32 offen offset:1152 sc1
    buffer_load_dwordx4 v[160:163], v7, s[4:7], s32 offen offset:1728 sc1
    s_mov_b64 exec, -1
    ds_read_b128 v[8:11], v10
    ds_read_b32 v12, v12
    v_cmp_gt_u32 vcc, 32, v0
    s_waitcnt lgkmcnt(0)
    s_nop 0
    v_cndmask_b32 v12, 0, v12, vcc
    v_mov_b32 v13, v12
    v_mov_b32 v165, v12
    v_mov_b32 v12, 0
    s_waitcnt vmcnt(18)
    v_mfma_f32_32x32x16_bf16 v[64:79], v[94:97], v[8:11], 0
    v_mfma_f32_32x32x16_bf16 v[64:79], v[92:95], v[12:15], v[64:79]
    s_cmp_lt_i32 s36, -7
    s_cbranch_scc1 B_FILL7
    v_mfma_f32_32x32x16_bf16 v[48:63], v[88:91], v[8:11], 0
    v_mfma_f32_32x32x16_bf16 v[48:63], v[86:89], v[12:15], v[48:63]
B_BK7:
    s_cmp_lt_i32 s36, -6
    s_cbranch_scc1 B_FILL6
    v_mfma_f32_32x32x16_bf16 v[32:47], v[82:85], v[8:11], 0
    v_mfma_f32_32x32x16_bf16 v[32:47], v[80:83], v[12:15], v[32:47]
B_BK6:
    buffer_load_dwordx4 v[82:85], v1, s[4:7], s27 offen sc1
    buffer_load_dword v81, v6, s[4:7], s27 offen offset:1024 sc1
    buffer_load_dwordx4 v[88:91], v1, s[4:7], s28 offen sc1
    buffer_load_dword v87, v6, s[4:7], s28 offen offset:1024 sc1
    buffer_load_dwordx4 v[94:97], v1, s[4:7], s29 offen sc1
    buffer_load_dword v93, v6, s[4:7], s29 offen offset:1024 sc1
    v_cndmask_b32 v64, v166, v64, s[64:65]
    v_cndmask_b32 v65, v166, v65, s[66:67]
    v_cndmask_b32 v66, v166, v66, s[68:69]
    v_cndmask_b32 v67, v166, v67, s[70:71]
    v_cndmask_b32 v68, v166, v68, s[72:73]
    v_cndmask_b32 v69, v166, v69, s[74:75]
    v_cndmask_b32 v70, v166, v70, s[76:77]
    v_cndmask_b32 v71, v166, v71, s[78:79]
    v_cndmask_b32 v72, v166, v72, s[80:81]
    v_cndmask_b32 v73, v166, v73, s[82:83]
    v_cndmask_b32 v74, v166, v74, s[84:85]
    v_cndmask_b32 v75, v166, v75, s[86:87]
    v_cndmask_b32 v76, v166, v76, s[88:89]
    v_cndmask_b32 v77, v166, v77, s[90:91]
    v_cndmask_b32 v78, v166, v78, s[92:93]
    v_cndmask_b32 v79, v166, v79, s[94:95]
    v_max3_f32 v4, v64, v65, v66
    v_max3_f32 v5, v67, v68, v69
    v_max3_f32 v4, v4, v70, v71
    v_max3_f32 v5, v5, v72, v73
    v_max3_f32 v4, v4, v74, v75
    v_max3_f32 v5, v5, v76, v77
    v_max3_f32 v4, v4, v78, v79
    v_max3_f32 v5, v5, v48, v49
    v_max3_f32 v4, v4, v50, v51
    v_max3_f32 v5, v5, v52, v53
    v_max3_f32 v4, v4, v54, v55
    v_max3_f32 v5, v5, v56, v57
    v_max3_f32 v4, v4, v58, v59
    v_max3_f32 v5, v5, v60, v61
    v_max3_f32 v4, v4, v62, v63
    v_max3_f32 v5, v5, v32, v33
    v_max3_f32 v4, v4, v34, v35
    v_max3_f32 v5, v5, v36, v37
    v_max3_f32 v4, v4, v38, v39
    v_max3_f32 v5, v5, v40, v41
    v_max3_f32 v4, v4, v42, v43
    v_max3_f32 v5, v5, v44, v45
    v_max3_f32 v4, v4, v46, v47
    v_max_f32 v4, v4, v5
    v_mov_b32 v5, v4
    s_nop 1
    v_permlane32_swap_b32 v4, v5
    v_max_f32 v4, v4, v5
    v_cvt_pk_bf16_f32 v5, -v4, -v4
    v_and_b32 v5, 0xffff0000, v5
    v_sub_f32 v4, -v4, v5
    v_cvt_pk_bf16_f32 v12, v5, v4
    v_mov_b32 v13, 0
    v_and_b32 v4, 0xffff0000, v12
    v_add_f32 v4, v4, v5
    v_mfma_f32_32x32x16_bf16 v[64:79], v[92:95], v[12:15], v[64:79]
    v_mfma_f32_32x32x16_bf16 v[48:63], v[86:89], v[12:15], v[48:63]
    v_mfma_f32_32x32x16_bf16 v[32:47], v[80:83], v[12:15], v[32:47]
    v_sub_f32 v164, 0, v4
    v_mov_b32 v12, 0
    v_mov_b32 v13, v165
    s_nop 6
    v_exp_f32 v64, v64
    v_exp_f32 v65, v65
    v_exp_f32 v66, v66
    v_exp_f32 v67, v67
    v_exp_f32 v68, v68
    v_exp_f32 v69, v69
    v_exp_f32 v70, v70
    v_exp_f32 v71, v71
    v_cvt_pk_bf16_f32 v64, v64, v65
    v_cvt_pk_bf16_f32 v65, v66, v67
    v_cvt_pk_bf16_f32 v66, v68, v69
    v_cvt_pk_bf16_f32 v67, v70, v71
    v_exp_f32 v72, v72
    v_exp_f32 v73, v73
    v_exp_f32 v74, v74
    v_exp_f32 v75, v75
    v_exp_f32 v76, v76
    v_exp_f32 v77, v77
    v_exp_f32 v78, v78
    v_exp_f32 v79, v79
    v_cvt_pk_bf16_f32 v68, v72, v73
    v_cvt_pk_bf16_f32 v69, v74, v75
    v_cvt_pk_bf16_f32 v70, v76, v77
    v_cvt_pk_bf16_f32 v71, v78, v79
    s_waitcnt vmcnt(18)
    v_mfma_f32_32x32x16_bf16 v[16:31], v[132:135], v[64:67], 0
    v_mfma_f32_32x32x16_bf16 v[16:31], v[136:139], v[68:71], v[16:31]
    v_exp_f32 v48, v48
    v_exp_f32 v49, v49
    v_exp_f32 v50, v50
    v_exp_f32 v51, v51
    v_exp_f32 v52, v52
    v_exp_f32 v53, v53
    v_exp_f32 v54, v54
    v_exp_f32 v55, v55
    v_cvt_pk_bf16_f32 v48, v48, v49
    v_cvt_pk_bf16_f32 v49, v50, v51
    v_cvt_pk_bf16_f32 v50, v52, v53
    v_cvt_pk_bf16_f32 v51, v54, v55
    v_exp_f32 v56, v56
    v_exp_f32 v57, v57
    v_exp_f32 v58, v58
    v_exp_f32 v59, v59
    v_exp_f32 v60, v60
    v_exp_f32 v61, v61
    v_exp_f32 v62, v62
    v_exp_f32 v63, v63
    v_cvt_pk_bf16_f32 v52, v56, v57
    v_cvt_pk_bf16_f32 v53, v58, v59
    v_cvt_pk_bf16_f32 v54, v60, v61
    v_cvt_pk_bf16_f32 v55, v62, v63
    v_mfma_f32_32x32x16_bf16 v[16:31], v[124:127], v[48:51], v[16:31]
    s_nop 0
    v_mfma_f32_32x32x16_bf16 v[16:31], v[128:131], v[52:55], v[16:31]
    v_exp_f32 v32, v32
    v_exp_f32 v33, v33
    v_exp_f32 v34, v34
    v_exp_f32 v35, v35
    v_exp_f32 v36, v36
    v_exp_f32 v37, v37
    v_exp_f32 v38, v38
    v_exp_f32 v39, v39
    v_cvt_pk_bf16_f32 v32, v32, v33
    v_cvt_pk_bf16_f32 v33, v34, v35
    v_cvt_pk_bf16_f32 v34, v36, v37
    v_cvt_pk_bf16_f32 v35, v38, v39
    v_exp_f32 v40, v40
    v_exp_f32 v41, v41
    v_exp_f32 v42, v42
    v_exp_f32 v43, v43
    v_exp_f32 v44, v44
    v_exp_f32 v45, v45
    v_exp_f32 v46, v46
    v_exp_f32 v47, v47
    v_cvt_pk_bf16_f32 v36, v40, v41
    v_cvt_pk_bf16_f32 v37, v42, v43
    v_cvt_pk_bf16_f32 v38, v44, v45
    v_cvt_pk_bf16_f32 v39, v46, v47
    v_mfma_f32_32x32x16_bf16 v[16:31], v[116:119], v[32:35], v[16:31]
    s_nop 0
    v_mfma_f32_32x32x16_bf16 v[16:31], v[120:123], v[36:39], v[16:31]
    s_mov_b32 exec_lo, 0x0011ffff
    s_mov_b32 exec_hi, 0x0011ffff
    buffer_load_dwordx4 v[116:119], v7, s[4:7], s27 offen offset:1152 sc1
    buffer_load_dwordx4 v[120:123], v7, s[4:7], s27 offen offset:1728 sc1
    buffer_load_dwordx4 v[124:127], v7, s[4:7], s28 offen offset:1152 sc1
    buffer_load_dwordx4 v[128:131], v7, s[4:7], s28 offen offset:1728 sc1
    buffer_load_dwordx4 v[132:135], v7, s[4:7], s29 offen offset:1152 sc1
    buffer_load_dwordx4 v[136:139], v7, s[4:7], s29 offen offset:1728 sc1
    s_mov_b64 exec, -1
    s_cmp_lt_i32 s36, -5
    s_cbranch_scc1 B_SKIP1
    s_waitcnt vmcnt(18)
    s_cmp_lt_i32 s36, -3
    s_cbranch_scc1 B_FILL3
    v_mfma_f32_32x32x16_bf16 v[32:47], v[100:103], v[8:11], 0
    v_mfma_f32_32x32x16_bf16 v[32:47], v[98:101], v[12:15], v[32:47]
B_BK3:
    s_cmp_lt_i32 s36, -4
    s_cbranch_scc1 B_FILL4
    v_mfma_f32_32x32x16_bf16 v[48:63], v[106:109], v[8:11], 0
    v_mfma_f32_32x32x16_bf16 v[48:63], v[104:107], v[12:15], v[48:63]
B_BK4:
    v_mfma_f32_32x32x16_bf16 v[64:79], v[112:115], v[8:11], 0
    v_mfma_f32_32x32x16_bf16 v[64:79], v[110:113], v[12:15], v[64:79]
    s_nop 5
    v_max3_f32 v4, v32, v33, v34
    v_max3_f32 v5, v35, v36, v37
    v_max3_f32 v4, v4, v38, v39
    v_max3_f32 v5, v5, v40, v41
    v_max3_f32 v4, v4, v42, v43
    v_max3_f32 v5, v5, v44, v45
    v_max3_f32 v4, v4, v46, v47
    v_max3_f32 v5, v5, v48, v49
    v_max3_f32 v4, v4, v50, v51
    v_max3_f32 v5, v5, v52, v53
    v_max3_f32 v4, v4, v54, v55
    v_max3_f32 v5, v5, v56, v57
    v_max3_f32 v4, v4, v58, v59
    v_max3_f32 v5, v5, v60, v61
    v_max3_f32 v4, v4, v62, v63
    v_max3_f32 v5, v5, v64, v65
    v_max3_f32 v4, v4, v66, v67
    v_max3_f32 v5, v5, v68, v69
    v_max3_f32 v4, v4, v70, v71
    v_max3_f32 v5, v5, v72, v73
    v_max3_f32 v4, v4, v74, v75
    v_max3_f32 v5, v5, v76, v77
    v_max3_f32 v4, v4, v78, v79
    v_max_f32 v4, v4, v5
    v_mov_b32 v5, v4
    s_nop 1
    v_permlane32_swap_b32 v4, v5
    v_max3_f32 v4, v4, v5, v164
    v_cvt_pk_bf16_f32 v5, -v4, -v4
    v_and_b32 v5, 0xffff0000, v5
    v_sub_f32 v4, -v4, v5
    v_cvt_pk_bf16_f32 v12, v5, v4
    v_mov_b32 v13, 0
    v_and_b32 v4, 0xffff0000, v12
    v_add_f32 v4, v4, v5
    v_mfma_f32_32x32x16_bf16 v[32:47], v[98:101], v[12:15], v[32:47]
    v_mfma_f32_32x32x16_bf16 v[48:63], v[104:107], v[12:15], v[48:63]
    v_mfma_f32_32x32x16_bf16 v[64:79], v[110:113], v[12:15], v[64:79]
    v_add_f32 v5, v164, v4
    v_exp_f32 v5, v5
    v_sub_f32 v164, 0, v4
    v_mov_b32 v12, 0
    v_mov_b32 v13, v165
    v_mul_f32 v16, v16, v5
    v_mul_f32 v17, v17, v5
    v_mul_f32 v18, v18, v5
    v_mul_f32 v19, v19, v5
    v_mul_f32 v20, v20, v5
    v_mul_f32 v21, v21, v5
    v_mul_f32 v22, v22, v5
    v_mul_f32 v23, v23, v5
    v_mul_f32 v24, v24, v5
    v_mul_f32 v25, v25, v5
    v_exp_f32 v32, v32
    v_exp_f32 v33, v33
    v_exp_f32 v34, v34
    v_exp_f32 v35, v35
    v_exp_f32 v36, v36
    v_exp_f32 v37, v37
    v_exp_f32 v38, v38
    v_exp_f32 v39, v39
    v_cvt_pk_bf16_f32 v32, v32, v33
    v_cvt_pk_bf16_f32 v33, v34, v35
    v_cvt_pk_bf16_f32 v34, v36, v37
    v_cvt_pk_bf16_f32 v35, v38, v39
    v_exp_f32 v40, v40
    v_exp_f32 v41, v41
    v_exp_f32 v42, v42
    v_exp_f32 v43, v43
    v_exp_f32 v44, v44
    v_exp_f32 v45, v45
    v_exp_f32 v46, v46
    v_exp_f32 v47, v47
    v_cvt_pk_bf16_f32 v36, v40, v41
    v_cvt_pk_bf16_f32 v37, v42, v43
    v_cvt_pk_bf16_f32 v38, v44, v45
    v_cvt_pk_bf16_f32 v39, v46, v47
    s_waitcnt vmcnt(12)
    v_mfma_f32_32x32x16_bf16 v[16:31], v[140:143], v[32:35], v[16:31]
    v_mfma_f32_32x32x16_bf16 v[16:31], v[144:147], v[36:39], v[16:31]
    v_exp_f32 v48, v48
    v_exp_f32 v49, v49
    v_exp_f32 v50, v50
    v_exp_f32 v51, v51
    v_exp_f32 v52, v52
    v_exp_f32 v53, v53
    v_exp_f32 v54, v54
    v_exp_f32 v55, v55
    v_cvt_pk_bf16_f32 v48, v48, v49
    v_cvt_pk_bf16_f32 v49, v50, v51
    v_cvt_pk_bf16_f32 v50, v52, v53
    v_cvt_pk_bf16_f32 v51, v54, v55
    v_exp_f32 v56, v56
    v_exp_f32 v57, v57
    v_exp_f32 v58, v58
    v_exp_f32 v59, v59
    v_exp_f32 v60, v60
    v_exp_f32 v61, v61
    v_exp_f32 v62, v62
    v_exp_f32 v63, v63
    v_cvt_pk_bf16_f32 v52, v56, v57
    v_cvt_pk_bf16_f32 v53, v58, v59
    v_cvt_pk_bf16_f32 v54, v60, v61
    v_cvt_pk_bf16_f32 v55, v62, v63
    v_mfma_f32_32x32x16_bf16 v[16:31], v[148:151], v[48:51], v[16:31]
    s_nop 0
    v_mfma_f32_32x32x16_bf16 v[16:31], v[152:155], v[52:55], v[16:31]
    v_exp_f32 v64, v64
    v_exp_f32 v65, v65
    v_exp_f32 v66, v66
    v_exp_f32 v67, v67
    v_exp_f32 v68, v68
    v_exp_f32 v69, v69
    v_exp_f32 v70, v70
    v_exp_f32 v71, v71
    v_cvt_pk_bf16_f32 v64, v64, v65
    v_cvt_pk_bf16_f32 v65, v66, v67
    v_cvt_pk_bf16_f32 v66, v68, v69
    v_cvt_pk_bf16_f32 v67, v70, v71
    v_exp_f32 v72, v72
    v_exp_f32 v73, v73
    v_exp_f32 v74, v74
    v_exp_f32 v75, v75
    v_exp_f32 v76, v76
    v_exp_f32 v77, v77
    v_exp_f32 v78, v78
    v_exp_f32 v79, v79
    v_cvt_pk_bf16_f32 v68, v72, v73
    v_cvt_pk_bf16_f32 v69, v74, v75
    v_cvt_pk_bf16_f32 v70, v76, v77
    v_cvt_pk_bf16_f32 v71, v78, v79
    v_mfma_f32_32x32x16_bf16 v[16:31], v[156:159], v[64:67], v[16:31]
    s_nop 0
    v_mfma_f32_32x32x16_bf16 v[16:31], v[160:163], v[68:71], v[16:31]
B_GE1:
    s_cmp_lt_i32 s36, -2
    s_cbranch_scc1 B_SKIP0
    s_waitcnt vmcnt(6)
    s_cmp_lt_i32 s36, 0
    s_cbranch_scc1 B_FILL0
    v_mfma_f32_32x32x16_bf16 v[32:47], v[82:85], v[8:11], 0
    v_mfma_f32_32x32x16_bf16 v[32:47], v[80:83], v[12:15], v[32:47]
B_BK0:
    s_cmp_lt_i32 s36, -1
    s_cbranch_scc1 B_FILL1
    v_mfma_f32_32x32x16_bf16 v[48:63], v[88:91], v[8:11], 0
    v_mfma_f32_32x32x16_bf16 v[48:63], v[86:89], v[12:15], v[48:63]
B_BK1:
    v_mfma_f32_32x32x16_bf16 v[64:79], v[94:97], v[8:11], 0
    v_mfma_f32_32x32x16_bf16 v[64:79], v[92:95], v[12:15], v[64:79]
    s_nop 5
    v_cndmask_b32 v32, v32, v166, s[64:65]
    v_cndmask_b32 v33, v33, v166, s[66:67]
    v_cndmask_b32 v34, v34, v166, s[68:69]
    v_cndmask_b32 v35, v35, v166, s[70:71]
    v_cndmask_b32 v36, v36, v166, s[72:73]
    v_cndmask_b32 v37, v37, v166, s[74:75]
    v_cndmask_b32 v38, v38, v166, s[76:77]
    v_cndmask_b32 v39, v39, v166, s[78:79]
    v_cndmask_b32 v40, v40, v166, s[80:81]
    v_cndmask_b32 v41, v41, v166, s[82:83]
    v_cndmask_b32 v42, v42, v166, s[84:85]
    v_cndmask_b32 v43, v43, v166, s[86:87]
    v_cndmask_b32 v44, v44, v166, s[88:89]
    v_cndmask_b32 v45, v45, v166, s[90:91]
    v_cndmask_b32 v46, v46, v166, s[92:93]
    v_cndmask_b32 v47, v47, v166, s[94:95]
    v_max3_f32 v4, v32, v33, v34
    v_max3_f32 v5, v35, v36, v37
    v_max3_f32 v4, v4, v38, v39
    v_max3_f32 v5, v5, v40, v41
    v_max3_f32 v4, v4, v42, v43
    v_max3_f32 v5, v5, v44, v45
    v_max3_f32 v4, v4, v46, v47
    v_max3_f32 v5, v5, v48, v49
    v_max3_f32 v4, v4, v50, v51
    v_max3_f32 v5, v5, v52, v53
    v_max3_f32 v4, v4, v54, v55
    v_max3_f32 v5, v5, v56, v57
    v_max3_f32 v4, v4, v58, v59
    v_max3_f32 v5, v5, v60, v61
    v_max3_f32 v4, v4, v62, v63
    v_max3_f32 v5, v5, v64, v65
    v_max3_f32 v4, v4, v66, v67
    v_max3_f32 v5, v5, v68, v69
    v_max3_f32 v4, v4, v70, v71
    v_max3_f32 v5, v5, v72, v73
    v_max3_f32 v4, v4, v74, v75
    v_max3_f32 v5, v5, v76, v77
    v_max3_f32 v4, v4, v78, v79
    v_max_f32 v4, v4, v5
    v_mov_b32 v5, v4
    s_nop 1
    v_permlane32_swap_b32 v4, v5
    v_max3_f32 v4, v4, v5, v164
    v_cvt_pk_bf16_f32 v5, -v4, -v4
    v_and_b32 v5, 0xffff0000, v5
    v_sub_f32 v4, -v4, v5
    v_cvt_pk_bf16_f32 v12, v5, v4
    v_mov_b32 v13, 0
    v_and_b32 v4, 0xffff0000, v12
    v_add_f32 v4, v4, v5
    v_mfma_f32_32x32x16_bf16 v[32:47], v[80:83], v[12:15], v[32:47]
    v_mfma_f32_32x32x16_bf16 v[48:63], v[86:89], v[12:15], v[48:63]
    v_mfma_f32_32x32x16_bf16 v[64:79], v[92:95], v[12:15], v[64:79]
    v_add_f32 v5, v164, v4
    v_exp_f32 v5, v5
    v_sub_f32 v164, 0, v4
    v_mul_f32 v16, v16, v5
    v_mul_f32 v17, v17, v5
    v_mul_f32 v18, v18, v5
    v_mul_f32 v19, v19, v5
    v_mul_f32 v20, v20, v5
    v_mul_f32 v21, v21, v5
    v_mul_f32 v22, v22, v5
    v_mul_f32 v23, v23, v5
    v_mul_f32 v24, v24, v5
    v_mul_f32 v25, v25, v5
    v_exp_f32 v32, v32
    v_exp_f32 v33, v33
    v_exp_f32 v34, v34
    v_exp_f32 v35, v35
    v_exp_f32 v36, v36
    v_exp_f32 v37, v37
    v_exp_f32 v38, v38
    v_exp_f32 v39, v39
    v_cvt_pk_bf16_f32 v32, v32, v33
    v_cvt_pk_bf16_f32 v33, v34, v35
    v_cvt_pk_bf16_f32 v34, v36, v37
    v_cvt_pk_bf16_f32 v35, v38, v39
    v_exp_f32 v40, v40
    v_exp_f32 v41, v41
    v_exp_f32 v42, v42
    v_exp_f32 v43, v43
    v_exp_f32 v44, v44
    v_exp_f32 v45, v45
    v_exp_f32 v46, v46
    v_exp_f32 v47, v47
    v_cvt_pk_bf16_f32 v36, v40, v41
    v_cvt_pk_bf16_f32 v37, v42, v43
    v_cvt_pk_bf16_f32 v38, v44, v45
    v_cvt_pk_bf16_f32 v39, v46, v47
    s_waitcnt vmcnt(0)
    v_mfma_f32_32x32x16_bf16 v[16:31], v[116:119], v[32:35], v[16:31]
    v_mfma_f32_32x32x16_bf16 v[16:31], v[120:123], v[36:39], v[16:31]
    v_exp_f32 v48, v48
    v_exp_f32 v49, v49
    v_exp_f32 v50, v50
    v_exp_f32 v51, v51
    v_exp_f32 v52, v52
    v_exp_f32 v53, v53
    v_exp_f32 v54, v54
    v_exp_f32 v55, v55
    v_cvt_pk_bf16_f32 v48, v48, v49
    v_cvt_pk_bf16_f32 v49, v50, v51
    v_cvt_pk_bf16_f32 v50, v52, v53
    v_cvt_pk_bf16_f32 v51, v54, v55
    v_exp_f32 v56, v56
    v_exp_f32 v57, v57
    v_exp_f32 v58, v58
    v_exp_f32 v59, v59
    v_exp_f32 v60, v60
    v_exp_f32 v61, v61
    v_exp_f32 v62, v62
    v_exp_f32 v63, v63
    v_cvt_pk_bf16_f32 v52, v56, v57
    v_cvt_pk_bf16_f32 v53, v58, v59
    v_cvt_pk_bf16_f32 v54, v60, v61
    v_cvt_pk_bf16_f32 v55, v62, v63
    v_mfma_f32_32x32x16_bf16 v[16:31], v[124:127], v[48:51], v[16:31]
    s_nop 0
    v_mfma_f32_32x32x16_bf16 v[16:31], v[128:131], v[52:55], v[16:31]
    v_exp_f32 v64, v64
    v_exp_f32 v65, v65
    v_exp_f32 v66, v66
    v_exp_f32 v67, v67
    v_exp_f32 v68, v68
    v_exp_f32 v69, v69
    v_exp_f32 v70, v70
    v_exp_f32 v71, v71
    v_cvt_pk_bf16_f32 v64, v64, v65
    v_cvt_pk_bf16_f32 v65, v66, v67
    v_cvt_pk_bf16_f32 v66, v68, v69
    v_cvt_pk_bf16_f32 v67, v70, v71
    v_exp_f32 v72, v72
    v_exp_f32 v73, v73
    v_exp_f32 v74, v74
    v_exp_f32 v75, v75
    v_exp_f32 v76, v76
    v_exp_f32 v77, v77
    v_exp_f32 v78, v78
    v_exp_f32 v79, v79
    v_cvt_pk_bf16_f32 v68, v72, v73
    v_cvt_pk_bf16_f32 v69, v74, v75
    v_cvt_pk_bf16_f32 v70, v76, v77
    v_cvt_pk_bf16_f32 v71, v78, v79
    v_mfma_f32_32x32x16_bf16 v[16:31], v[132:135], v[64:67], v[16:31]
    s_nop 0
    v_mfma_f32_32x32x16_bf16 v[16:31], v[136:139], v[68:71], v[16:31]
B_GE0:
    v_and_b32 v2, 31, v0
    s_lshl_b32 s39, s38, 5
    v_add_u32 v2, s39, v2
    v_mul_u32_u24 v2, 144, v2
    v_lshrrev_b32 v3, 5, v0
    v_mad_u32_u24 v2, v3, 18, v2
    s_mul_i32 s39, s37, 36
    s_add_u32 s39, s39, 90112
    v_add_u32 v2, s39, v2
    s_nop 4
    v_rcp_f32 v4, v25
    s_nop 0
    v_mul_f32 v16, v16, v4
    v_mul_f32 v17, v17, v4
    v_mul_f32 v18, v18, v4
    v_mul_f32 v19, v19, v4
    v_mul_f32 v20, v20, v4
    v_mul_f32 v21, v21, v4
    v_mul_f32 v22, v22, v4
    v_mul_f32 v23, v23, v4
    v_mul_f32 v24, v24, v4
    v_cvt_pk_bf16_f32 v32, v16, v17
    v_cvt_pk_bf16_f32 v33, v18, v19
    v_cvt_pk_bf16_f32 v34, v20, v21
    v_cvt_pk_bf16_f32 v35, v22, v23
    v_cvt_pk_bf16_f32 v36, v24, v24
    ds_write_b16 v2, v32 offset:0
    ds_write_b16_d16_hi v2, v32 offset:2
    ds_write_b16 v2, v33 offset:4
    ds_write_b16_d16_hi v2, v33 offset:6
    ds_write_b16 v2, v34 offset:8
    ds_write_b16_d16_hi v2, v34 offset:10
    ds_write_b16 v2, v35 offset:12
    ds_write_b16_d16_hi v2, v35 offset:14
    ds_write_b16 v2, v36 offset:16
    s_branch B_DONE2
B_DONE:
    s_mov_b32 s26, s41
    buffer_load_dwordx4 v[8:11], v1, s[4:7], s26 offen
    buffer_load_dwordx4 v[12:15], v1, s[4:7], s26 offen offset:1024
    buffer_load_dwordx4 v[16:19], v1, s[4:7], s26 offen offset:2048
    buffer_load_dwordx4 v[20:23], v1, s[4:7], s26 offen offset:3072
    s_add_u32 s26, s26, 4096
    buffer_load_dwordx4 v[24:27], v1, s[4:7], s26 offen
    buffer_load_dwordx4 v[28:31], v1, s[4:7], s26 offen offset:1024
    buffer_load_dwordx4 v[32:35], v1, s[4:7], s26 offen offset:2048
    buffer_load_dwordx4 v[36:39], v1, s[4:7], s26 offen offset:3072
    s_add_u32 s26, s26, 4096
    buffer_load_dwordx4 v[40:43], v1, s[4:7], s26 offen
    buffer_load_dwordx4 v[44:47], v1, s[4:7], s26 offen offset:1024
    buffer_load_dwordx4 v[48:51], v1, s[4:7], s26 offen offset:2048
    buffer_load_dwordx4 v[52:55], v1, s[4:7], s26 offen offset:3072
    s_add_u32 s26, s26, 4096
    buffer_load_dwordx4 v[56:59], v1, s[4:7], s26 offen
    buffer_load_dwordx4 v[60:63], v1, s[4:7], s26 offen offset:1024
    buffer_load_dwordx4 v[64:67], v1, s[4:7], s26 offen offset:2048
    buffer_load_dwordx4 v[68:71], v1, s[4:7], s26 offen offset:3072
    s_add_u32 s26, s26, 4096
    buffer_load_dwordx4 v[72:75], v1, s[4:7], s26 offen
    buffer_load_dwordx4 v[76:79], v1, s[4:7], s26 offen offset:1024
B_DONE2:
    s_waitcnt lgkmcnt(0)
    s_barrier
    s_cmp_ge_u32 s22, 9
    s_cbranch_scc1 B_ST
    v_mul_u32_u24 v4, 144, v0
    s_lshl_b32 s27, s22, 4
    s_add_u32 s27, s27, 90112
    v_add_u32 v4, s27, v4
    ds_read_b128 v[4:7], v4
    s_mul_i32 s27, s21, 9
    s_add_u32 s27, s27, s22
    s_lshr_b32 s28, s27, 2
    s_lshl_b32 s28, s28, 12
    s_and_b32 s27, s27, 3
    s_lshl_b32 s27, s27, 8
    s_add_u32 s28, s28, s27
    v_lshrrev_b32 v2, 4, v0
    v_lshlrev_b32 v2, 10, v2
    v_and_b32 v3, 15, v0
    v_lshl_add_u32 v2, v3, 4, v2
    v_add_u32 v2, s28, v2
    s_mul_i32 s29, s20, 73728
    s_add_u32 s29, s29, 23904256
    s_mul_i32 s96, s23, 2359296
    s_add_u32 s29, s29, s96
    s_waitcnt lgkmcnt(0)
    buffer_store_dwordx4 v[4:7], v2, s[4:7], s29 offen sc1
B_ST:
    s_waitcnt vmcnt(0) lgkmcnt(0)
    s_barrier
    s_cmp_lg_u32 s22, 0
    s_cbranch_scc1 Lf12
    s_add_u32 s27, s24, 2
    s_lshl_b32 s28, s20, 8
    s_lshl_b32 s29, s21, 2
    s_add_u32 s28, s28, s29
    v_mov_b32 v2, s27
    v_mov_b32 v3, 0
    s_mov_b64 exec, 1
    buffer_store_dword v2, v3, s[4:7], s28 offen sc1
    s_mov_b64 exec, -1
Lf12:
    s_cmp_ge_u32 s22, 2
    s_cbranch_scc1 B2_NP
    s_mov_b32 s26, s41
    buffer_load_dwordx4 v[8:11], v1, s[4:7], s26 offen
    buffer_load_dwordx4 v[12:15], v1, s[4:7], s26 offen offset:1024
    buffer_load_dwordx4 v[16:19], v1, s[4:7], s26 offen offset:2048
    buffer_load_dwordx4 v[20:23], v1, s[4:7], s26 offen offset:3072
    s_add_u32 s26, s26, 4096
    buffer_load_dwordx4 v[24:27], v1, s[4:7], s26 offen
    buffer_load_dwordx4 v[28:31], v1, s[4:7], s26 offen offset:1024
    buffer_load_dwordx4 v[32:35], v1, s[4:7], s26 offen offset:2048
    buffer_load_dwordx4 v[36:39], v1, s[4:7], s26 offen offset:3072
    s_add_u32 s26, s26, 4096
    buffer_load_dwordx4 v[40:43], v1, s[4:7], s26 offen
    buffer_load_dwordx4 v[44:47], v1, s[4:7], s26 offen offset:1024
    buffer_load_dwordx4 v[48:51], v1, s[4:7], s26 offen offset:2048
    buffer_load_dwordx4 v[52:55], v1, s[4:7], s26 offen offset:3072
    s_add_u32 s26, s26, 4096
    buffer_load_dwordx4 v[56:59], v1, s[4:7], s26 offen
    buffer_load_dwordx4 v[60:63], v1, s[4:7], s26 offen offset:1024
    buffer_load_dwordx4 v[64:67], v1, s[4:7], s26 offen offset:2048
    buffer_load_dwordx4 v[68:71], v1, s[4:7], s26 offen offset:3072
    s_add_u32 s26, s26, 4096
    buffer_load_dwordx4 v[72:75], v1, s[4:7], s26 offen
    buffer_load_dwordx4 v[76:79], v1, s[4:7], s26 offen offset:1024
B2_NP:
    s_cmp_lg_u32 s22, 2
    s_cbranch_scc1 Lp13
    s_cmp_lg_u32 s25, 0
    s_cbranch_scc1 Lp13
    s_mov_b32 s30, 0xff
    s_mov_b32 s31, 0
    v_lshlrev_b32 v2, 2, v0
    s_lshl_b32 s28, s20, 8
    s_bitset0_b32 s30, s21
    s_add_u32 s27, s24, 2
    s_mov_b32 s29, 400000
    s_mov_b64 exec, s[30:31]
Lpl14:
    buffer_load_dword v3, v2, s[4:7], s28 offen sc1
    s_waitcnt vmcnt(0)
    v_cmp_gt_u32 vcc, s27, v3
    s_nop 1
    s_cbranch_vccz Lpd15
    s_sub_u32 s29, s29, 1
    s_cbranch_scc0 Lpl14
    s_mov_b32 s25, 1
Lpd15:
    s_mov_b64 exec, -1
Lp13:
    s_barrier
    s_mul_i32 s29, s20, 73728
    s_add_u32 s29, s29, 23904256
    s_mul_i32 s96, s23, 2359296
    s_add_u32 s29, s29, s96
    s_lshr_b32 s27, s22, 2
    s_mul_i32 s27, s27, 24576
    s_and_b32 s28, s22, 3
    s_lshl_b32 s28, s28, 10
    s_add_u32 s27, s27, s28
    s_add_u32 s28, s27, s29
    buffer_load_dwordx4 v[128:131], v1, s[4:7], s28 offen sc1
    s_add_u32 s28, s28, 4096
    buffer_load_dwordx4 v[132:135], v1, s[4:7], s28 offen sc1
    s_add_u32 s28, s28, 4096
    buffer_load_dwordx4 v[136:139], v1, s[4:7], s28 offen sc1
    s_add_u32 s28, s28, 4096
    buffer_load_dwordx4 v[140:143], v1, s[4:7], s28 offen sc1
    s_add_u32 s28, s28, 4096
    buffer_load_dwordx4 v[144:147], v1, s[4:7], s28 offen sc1
    s_add_u32 s28, s28, 4096
    buffer_load_dwordx4 v[148:151], v1, s[4:7], s28 offen sc1
    s_lshr_b32 s27, s22, 2
    s_mul_i32 s27, s27, 24576
    s_and_b32 s28, s22, 3
    s_lshl_b32 s28, s28, 10
    s_add_u32 s27, s27, s28
    v_add_u32 v4, s27, v1
    s_cmp_lt_u32 s22, 2
    s_cbranch_scc1 B2_P
    s_waitcnt vmcnt(5)
    ds_write_b128 v4, v[128:131] offset:0
    s_waitcnt vmcnt(4)
    ds_write_b128 v4, v[132:135] offset:4096
    s_waitcnt vmcnt(3)
    ds_write_b128 v4, v[136:139] offset:8192
    s_waitcnt vmcnt(2)
    ds_write_b128 v4, v[140:143] offset:12288
    s_waitcnt vmcnt(1)
    ds_write_b128 v4, v[144:147] offset:16384
    s_waitcnt vmcnt(0)
    ds_write_b128 v4, v[148:151] offset:20480
    s_branch B2_Q
B2_P:
    s_waitcnt vmcnt(5)
    ds_write_b128 v4, v[128:131] offset:0
    s_waitcnt vmcnt(4)
    ds_write_b128 v4, v[132:135] offset:4096
    s_waitcnt vmcnt(3)
    ds_write_b128 v4, v[136:139] offset:8192
    s_waitcnt vmcnt(2)
    ds_write_b128 v4, v[140:143] offset:12288
    s_waitcnt vmcnt(1)
    ds_write_b128 v4, v[144:147] offset:16384
    s_waitcnt vmcnt(0)
    ds_write_b128 v4, v[148:151] offset:20480
B2_Q:
    s_waitcnt lgkmcnt(0)
    s_barrier
    s_cmp_ge_u32 s22, 8
    s_cbranch_scc1 B2_F
    s_cmp_lt_u32 s22, 2
    s_cbranch_scc1 B2_G
    s_cmp_lg_u32 s23, 0
    s_cbranch_scc1 B2_W
    v_and_b32 v2, 31, v0
    v_lshlrev_b32 v2, 8, v2
    s_lshl_b32 s28, s21, 2
    s_cmp_lg_u32 s25, 0
    s_cbranch_scc1 Lsd17
    s_mov_b32 s29, 400000
Lsl16:
    buffer_load_dword v3, v2, s[4:7], s28 offen sc1
    s_waitcnt vmcnt(0)
    v_cmp_gt_u32 vcc, 3, v3
    s_nop 1
    s_cbranch_vccz Lsd17
    s_sub_u32 s29, s29, 1
    s_cbranch_scc0 Lsl16
    s_mov_b32 s25, 1
Lsd17:
B2_W:
    s_mov_b32 s26, s42
    buffer_load_dwordx4 v[8:11], v1, s[4:7], s26 offen
    buffer_load_dwordx4 v[12:15], v1, s[4:7], s26 offen offset:1024
    buffer_load_dwordx4 v[16:19], v1, s[4:7], s26 offen offset:2048
    buffer_load_dwordx4 v[20:23], v1, s[4:7], s26 offen offset:3072
    s_add_u32 s26, s26, 4096
    buffer_load_dwordx4 v[24:27], v1, s[4:7], s26 offen
    buffer_load_dwordx4 v[28:31], v1, s[4:7], s26 offen offset:1024
    buffer_load_dwordx4 v[32:35], v1, s[4:7], s26 offen offset:2048
    buffer_load_dwordx4 v[36:39], v1, s[4:7], s26 offen offset:3072
    s_add_u32 s26, s26, 4096
    buffer_load_dwordx4 v[40:43], v1, s[4:7], s26 offen
    buffer_load_dwordx4 v[44:47], v1, s[4:7], s26 offen offset:1024
    buffer_load_dwordx4 v[48:51], v1, s[4:7], s26 offen offset:2048
    buffer_load_dwordx4 v[52:55], v1, s[4:7], s26 offen offset:3072
    s_add_u32 s26, s26, 4096
    buffer_load_dwordx4 v[56:59], v1, s[4:7], s26 offen
    buffer_load_dwordx4 v[60:63], v1, s[4:7], s26 offen offset:1024
    buffer_load_dwordx4 v[64:67], v1, s[4:7], s26 offen offset:2048
    buffer_load_dwordx4 v[68:71], v1, s[4:7], s26 offen offset:3072
    s_add_u32 s26, s26, 4096
    buffer_load_dwordx4 v[72:75], v1, s[4:7], s26 offen
    buffer_load_dwordx4 v[76:79], v1, s[4:7], s26 offen offset:1024
    s_branch B2_DONE
    s_cmp_lg_u32 s22, 7
    s_cbranch_scc1 B2_DONE
    s_cmp_lg_u32 s23, 0
    s_cbranch_scc1 B2_DONE
    v_and_b32 v2, 31, v0
    v_lshlrev_b32 v2, 8, v2
    s_lshl_b32 s28, s21, 2
    s_cmp_lg_u32 s25, 0
    s_cbranch_scc1 Lsd19
    s_mov_b32 s29, 400000
Lsl18:
    buffer_load_dword v3, v2, s[4:7], s28 offen sc1
    s_waitcnt vmcnt(0)
    v_cmp_gt_u32 vcc, 3, v3
    s_nop 1
    s_cbranch_vccz Lsd19
    s_sub_u32 s29, s29, 1
    s_cbranch_scc0 Lsl18
    s_mov_b32 s25, 1
Lsd19:
    s_branch B2_DONE
B2_G:
    s_mov_b32 s27, 4
    s_lshl_b32 s30, s27, 11
    s_add_u32 s30, s30, 147456
    v_lshrrev_b32 v3, 5, v0
    v_and_b32 v2, 31, v0
    v_lshlrev_b32 v2, 4, v2
    v_lshl_add_u32 v2, v3, 10, v2
    v_add_u32 v5, s30, v2
    s_mul_i32 s30, s21, 9
    s_lshl_b32 s31, s27, 1
    s_add_u32 s30, s30, s31
    v_add_u32 v3, s30, v3
    v_lshrrev_b32 v2, 2, v3
    v_lshlrev_b32 v2, 12, v2
    v_and_b32 v3, 3, v3
    v_lshl_add_u32 v2, v3, 8, v2
    v_bfe_u32 v3, v0, 4, 1
    v_lshl_add_u32 v2, v3, 10, v2
    v_and_b32 v3, 15, v0
    v_lshl_add_u32 v2, v3, 4, v2
    s_mul_i32 s29, s20, 73728
    s_add_u32 s29, s29, 28622848
    s_mul_i32 s96, s23, 2359296
    s_add_u32 s29, s29, s96
    s_mov_b32 s30, 0xffff0000
    s_lshl_b32 s28, s22, 9
    v_add_u32 v5, s28, v5
    s_lshl_b32 s28, s22, 11
    s_add_u32 s29, s29, s28
    s_mov_b32 exec_hi, 0
    ds_read_b128 v[100:103], v5
    s_mov_b32 exec_hi, -1
    s_and_b32 s27, s22, 1
    s_lshl_b32 s27, s27, 11
    s_add_u32 s27, s27, 0
    v_add_u32 v6, s27, v1
    v_add_u32 v7, 36864, v6
    ds_read_b128 v[128:131], v6 offset:0
    ds_read_b128 v[132:135], v6 offset:1024
    ds_read_b128 v[144:147], v6 offset:4096
    ds_read_b128 v[148:151], v6 offset:5120
    s_waitcnt vmcnt(17) lgkmcnt(2)
    v_mfma_f32_16x16x32_bf16 v[80:83], v[8:11], v[128:131], 0
    v_mfma_f32_16x16x32_bf16 v[84:87], v[8:11], v[132:135], 0
    ds_read_b128 v[128:131], v6 offset:8192
    ds_read_b128 v[132:135], v6 offset:9216
    s_waitcnt vmcnt(16) lgkmcnt(2)
    v_mfma_f32_16x16x32_bf16 v[80:83], v[12:15], v[144:147], v[80:83]
    v_mfma_f32_16x16x32_bf16 v[84:87], v[12:15], v[148:151], v[84:87]
    ds_read_b128 v[144:147], v6 offset:12288
    ds_read_b128 v[148:151], v6 offset:13312
    s_waitcnt vmcnt(15) lgkmcnt(2)
    v_mfma_f32_16x16x32_bf16 v[80:83], v[16:19], v[128:131], v[80:83]
    v_mfma_f32_16x16x32_bf16 v[84:87], v[16:19], v[132:135], v[84:87]
    ds_read_b128 v[128:131], v6 offset:16384
    ds_read_b128 v[132:135], v6 offset:17408
    s_waitcnt vmcnt(14) lgkmcnt(2)
    v_mfma_f32_16x16x32_bf16 v[80:83], v[20:23], v[144:147], v[80:83]
    v_mfma_f32_16x16x32_bf16 v[84:87], v[20:23], v[148:151], v[84:87]
    ds_read_b128 v[144:147], v6 offset:20480
    ds_read_b128 v[148:151], v6 offset:21504
    s_waitcnt vmcnt(13) lgkmcnt(2)
    v_mfma_f32_16x16x32_bf16 v[80:83], v[24:27], v[128:131], v[80:83]
    v_mfma_f32_16x16x32_bf16 v[84:87], v[24:27], v[132:135], v[84:87]
    ds_read_b128 v[128:131], v6 offset:24576
    ds_read_b128 v[132:135], v6 offset:25600
    s_waitcnt vmcnt(12) lgkmcnt(2)
    v_mfma_f32_16x16x32_bf16 v[80:83], v[28:31], v[144:147], v[80:83]
    v_mfma_f32_16x16x32_bf16 v[84:87], v[28:31], v[148:151], v[84:87]
    ds_read_b128 v[144:147], v6 offset:28672
    ds_read_b128 v[148:151], v6 offset:29696
    s_waitcnt vmcnt(11) lgkmcnt(2)
    v_mfma_f32_16x16x32_bf16 v[80:83], v[32:35], v[128:131], v[80:83]
    v_mfma_f32_16x16x32_bf16 v[84:87], v[32:35], v[132:135], v[84:87]
    ds_read_b128 v[128:131], v6 offset:32768
    ds_read_b128 v[132:135], v6 offset:33792
    s_waitcnt vmcnt(10) lgkmcnt(2)
    v_mfma_f32_16x16x32_bf16 v[80:83], v[36:39], v[144:147], v[80:83]
    v_mfma_f32_16x16x32_bf16 v[84:87], v[36:39], v[148:151], v[84:87]
    ds_read_b128 v[144:147], v7 offset:0
    ds_read_b128 v[148:151], v7 offset:1024
    s_waitcnt vmcnt(9) lgkmcnt(2)
    v_mfma_f32_16x16x32_bf16 v[80:83], v[40:43], v[128:131], v[80:83]
    v_mfma_f32_16x16x32_bf16 v[84:87], v[40:43], v[132:135], v[84:87]
    ds_read_b128 v[128:131], v7 offset:4096
    ds_read_b128 v[132:135], v7 offset:5120
    s_waitcnt vmcnt(8) lgkmcnt(2)
    v_mfma_f32_16x16x32_bf16 v[80:83], v[44:47], v[144:147], v[80:83]
    v_mfma_f32_16x16x32_bf16 v[84:87], v[44:47], v[148:151], v[84:87]
    ds_read_b128 v[144:147], v7 offset:8192
    ds_read_b128 v[148:151], v7 offset:9216
    s_waitcnt vmcnt(7) lgkmcnt(2)
    v_mfma_f32_16x16x32_bf16 v[80:83], v[48:51], v[128:131], v[80:83]
    v_mfma_f32_16x16x32_bf16 v[84:87], v[48:51], v[132:135], v[84:87]
    ds_read_b128 v[128:131], v7 offset:12288
    ds_read_b128 v[132:135], v7 offset:13312
    s_waitcnt vmcnt(6) lgkmcnt(2)
    v_mfma_f32_16x16x32_bf16 v[80:83], v[52:55], v[144:147], v[80:83]
    v_mfma_f32_16x16x32_bf16 v[84:87], v[52:55], v[148:151], v[84:87]
    ds_read_b128 v[144:147], v7 offset:16384
    ds_read_b128 v[148:151], v7 offset:17408
    s_waitcnt vmcnt(5) lgkmcnt(2)
    v_mfma_f32_16x16x32_bf16 v[80:83], v[56:59], v[128:131], v[80:83]
    v_mfma_f32_16x16x32_bf16 v[84:87], v[56:59], v[132:135], v[84:87]
    ds_read_b128 v[128:131], v7 offset:20480
    ds_read_b128 v[132:135], v7 offset:21504
    s_waitcnt vmcnt(4) lgkmcnt(2)
    v_mfma_f32_16x16x32_bf16 v[80:83], v[60:63], v[144:147], v[80:83]
    v_mfma_f32_16x16x32_bf16 v[84:87], v[60:63], v[148:151], v[84:87]
    ds_read_b128 v[144:147], v7 offset:24576
    ds_read_b128 v[148:151], v7 offset:25600
    s_waitcnt vmcnt(3) lgkmcnt(2)
    v_mfma_f32_16x16x32_bf16 v[80:83], v[64:67], v[128:131], v[80:83]
    v_mfma_f32_16x16x32_bf16 v[84:87], v[64:67], v[132:135], v[84:87]
    ds_read_b128 v[128:131], v7 offset:28672
    ds_read_b128 v[132:135], v7 offset:29696
    s_waitcnt vmcnt(2) lgkmcnt(2)
    v_mfma_f32_16x16x32_bf16 v[80:83], v[68:71], v[144:147], v[80:83]
    v_mfma_f32_16x16x32_bf16 v[84:87], v[68:71], v[148:151], v[84:87]
    ds_read_b128 v[144:147], v7 offset:32768
    ds_read_b128 v[148:151], v7 offset:33792
    s_waitcnt vmcnt(1) lgkmcnt(2)
    v_mfma_f32_16x16x32_bf16 v[80:83], v[72:75], v[128:131], v[80:83]
    v_mfma_f32_16x16x32_bf16 v[84:87], v[72:75], v[132:135], v[84:87]
    s_waitcnt vmcnt(0) lgkmcnt(0)
    v_mfma_f32_16x16x32_bf16 v[80:83], v[76:79], v[144:147], v[80:83]
    v_mfma_f32_16x16x32_bf16 v[84:87], v[76:79], v[148:151], v[84:87]
    s_nop 7
    v_permlane16_swap_b32 v80, v84
    v_permlane16_swap_b32 v81, v85
    v_permlane16_swap_b32 v82, v86
    v_permlane16_swap_b32 v83, v87
    v_lshlrev_b32 v132, 16, v100
    v_and_b32 v133, s30, v100
    v_add_f32 v80, v80, v132
    v_add_f32 v81, v81, v133
    v_cvt_pk_bf16_f32 v100, v80, v81
    v_lshlrev_b32 v132, 16, v101
    v_and_b32 v133, s30, v101
    v_add_f32 v82, v82, v132
    v_add_f32 v83, v83, v133
    v_cvt_pk_bf16_f32 v101, v82, v83
    v_lshlrev_b32 v132, 16, v102
    v_and_b32 v133, s30, v102
    v_add_f32 v84, v84, v132
    v_add_f32 v85, v85, v133
    v_cvt_pk_bf16_f32 v102, v84, v85
    v_lshlrev_b32 v132, 16, v103
    v_and_b32 v133, s30, v103
    v_add_f32 v86, v86, v132
    v_add_f32 v87, v87, v133
    v_cvt_pk_bf16_f32 v103, v86, v87
    s_mov_b32 exec_hi, 0
    buffer_store_dwordx4 v[100:103], v2, s[4:7], s29 offen offset:0 sc1
    ds_write_b128 v5, v[100:103] offset:0
    s_mov_b32 exec_hi, -1
    s_branch B2_DONE
B2_F:
    s_sub_u32 s27, s22, 8
    s_lshl_b32 s30, s27, 11
    s_add_u32 s30, s30, 147456
    v_lshrrev_b32 v3, 5, v0
    v_and_b32 v2, 31, v0
    v_lshlrev_b32 v2, 4, v2
    v_lshl_add_u32 v2, v3, 10, v2
    v_add_u32 v5, s30, v2
    s_mul_i32 s30, s21, 9
    s_lshl_b32 s31, s27, 1
    s_add_u32 s30, s30, s31
    v_add_u32 v3, s30, v3
    v_lshrrev_b32 v2, 2, v3
    v_lshlrev_b32 v2, 12, v2
    v_and_b32 v3, 3, v3
    v_lshl_add_u32 v2, v3, 8, v2
    v_bfe_u32 v3, v0, 4, 1
    v_lshl_add_u32 v2, v3, 10, v2
    v_and_b32 v3, 15, v0
    v_lshl_add_u32 v2, v3, 4, v2
    s_mul_i32 s29, s20, 73728
    s_add_u32 s29, s29, 28622848
    s_mul_i32 s96, s23, 2359296
    s_add_u32 s29, s29, s96
    s_mov_b32 s30, 0xffff0000
    ds_read_b128 v[100:103], v5
    ds_read_b128 v[104:107], v5 offset:512
    v_add_u32 v6, 0, v1
    v_add_u32 v7, 36864, v6
    ds_read_b128 v[128:131], v6 offset:0
    ds_read_b128 v[132:135], v6 offset:1024
    ds_read_b128 v[136:139], v6 offset:2048
    ds_read_b128 v[140:143], v6 offset:3072
    ds_read_b128 v[144:147], v6 offset:4096
    ds_read_b128 v[148:151], v6 offset:5120
    ds_read_b128 v[152:155], v6 offset:6144
    ds_read_b128 v[156:159], v6 offset:7168
    s_waitcnt lgkmcnt(4)
    v_mfma_f32_16x16x32_bf16 v[80:83], v[8:11], v[128:131], 0
    v_mfma_f32_16x16x32_bf16 v[84:87], v[8:11], v[132:135], 0
    v_mfma_f32_16x16x32_bf16 v[88:91], v[8:11], v[136:139], 0
    v_mfma_f32_16x16x32_bf16 v[92:95], v[8:11], v[140:143], 0
    ds_read_b128 v[128:131], v6 offset:8192
    ds_read_b128 v[132:135], v6 offset:9216
    ds_read_b128 v[136:139], v6 offset:10240
    ds_read_b128 v[140:143], v6 offset:11264
    s_waitcnt lgkmcnt(4)
    v_mfma_f32_16x16x32_bf16 v[80:83], v[12:15], v[144:147], v[80:83]
    v_mfma_f32_16x16x32_bf16 v[84:87], v[12:15], v[148:151], v[84:87]
    v_mfma_f32_16x16x32_bf16 v[88:91], v[12:15], v[152:155], v[88:91]
    v_mfma_f32_16x16x32_bf16 v[92:95], v[12:15], v[156:159], v[92:95]
    ds_read_b128 v[144:147], v6 offset:12288
    ds_read_b128 v[148:151], v6 offset:13312
    ds_read_b128 v[152:155], v6 offset:14336
    ds_read_b128 v[156:159], v6 offset:15360
    s_waitcnt lgkmcnt(4)
    v_mfma_f32_16x16x32_bf16 v[80:83], v[16:19], v[128:131], v[80:83]
    v_mfma_f32_16x16x32_bf16 v[84:87], v[16:19], v[132:135], v[84:87]
    v_mfma_f32_16x16x32_bf16 v[88:91], v[16:19], v[136:139], v[88:91]
    v_mfma_f32_16x16x32_bf16 v[92:95], v[16:19], v[140:143], v[92:95]
    ds_read_b128 v[128:131], v6 offset:16384
    ds_read_b128 v[132:135], v6 offset:17408
    ds_read_b128 v[136:139], v6 offset:18432
    ds_read_b128 v[140:143], v6 offset:19456
    s_waitcnt lgkmcnt(4)
    v_mfma_f32_16x16x32_bf16 v[80:83], v[20:23], v[144:147], v[80:83]
    v_mfma_f32_16x16x32_bf16 v[84:87], v[20:23], v[148:151], v[84:87]
    v_mfma_f32_16x16x32_bf16 v[88:91], v[20:23], v[152:155], v[88:91]
    v_mfma_f32_16x16x32_bf16 v[92:95], v[20:23], v[156:159], v[92:95]
    ds_read_b128 v[144:147], v6 offset:20480
    ds_read_b128 v[148:151], v6 offset:21504
    ds_read_b128 v[152:155], v6 offset:22528
    ds_read_b128 v[156:159], v6 offset:23552
    s_waitcnt lgkmcnt(4)
    v_mfma_f32_16x16x32_bf16 v[80:83], v[24:27], v[128:131], v[80:83]
    v_mfma_f32_16x16x32_bf16 v[84:87], v[24:27], v[132:135], v[84:87]
    v_mfma_f32_16x16x32_bf16 v[88:91], v[24:27], v[136:139], v[88:91]
    v_mfma_f32_16x16x32_bf16 v[92:95], v[24:27], v[140:143], v[92:95]
    ds_read_b128 v[128:131], v6 offset:24576
    ds_read_b128 v[132:135], v6 offset:25600
    ds_read_b128 v[136:139], v6 offset:26624
    ds_read_b128 v[140:143], v6 offset:27648
    s_waitcnt lgkmcnt(4)
    v_mfma_f32_16x16x32_bf16 v[80:83], v[28:31], v[144:147], v[80:83]
    v_mfma_f32_16x16x32_bf16 v[84:87], v[28:31], v[148:151], v[84:87]
    v_mfma_f32_16x16x32_bf16 v[88:91], v[28:31], v[152:155], v[88:91]
    v_mfma_f32_16x16x32_bf16 v[92:95], v[28:31], v[156:159], v[92:95]
    ds_read_b128 v[144:147], v6 offset:28672
    ds_read_b128 v[148:151], v6 offset:29696
    ds_read_b128 v[152:155], v6 offset:30720
    ds_read_b128 v[156:159], v6 offset:31744
    s_waitcnt lgkmcnt(4)
    v_mfma_f32_16x16x32_bf16 v[80:83], v[32:35], v[128:131], v[80:83]
    v_mfma_f32_16x16x32_bf16 v[84:87], v[32:35], v[132:135], v[84:87]
    v_mfma_f32_16x16x32_bf16 v[88:91], v[32:35], v[136:139], v[88:91]
    v_mfma_f32_16x16x32_bf16 v[92:95], v[32:35], v[140:143], v[92:95]
    ds_read_b128 v[128:131], v6 offset:32768
    ds_read_b128 v[132:135], v6 offset:33792
    ds_read_b128 v[136:139], v6 offset:34816
    ds_read_b128 v[140:143], v6 offset:35840
    s_waitcnt lgkmcnt(4)
    v_mfma_f32_16x16x32_bf16 v[80:83], v[36:39], v[144:147], v[80:83]
    v_mfma_f32_16x16x32_bf16 v[84:87], v[36:39], v[148:151], v[84:87]
    v_mfma_f32_16x16x32_bf16 v[88:91], v[36:39], v[152:155], v[88:91]
    v_mfma_f32_16x16x32_bf16 v[92:95], v[36:39], v[156:159], v[92:95]
    ds_read_b128 v[144:147], v7 offset:0
    ds_read_b128 v[148:151], v7 offset:1024
    ds_read_b128 v[152:155], v7 offset:2048
    ds_read_b128 v[156:159], v7 offset:3072
    s_waitcnt lgkmcnt(4)
    v_mfma_f32_16x16x32_bf16 v[80:83], v[40:43], v[128:131], v[80:83]
    v_mfma_f32_16x16x32_bf16 v[84:87], v[40:43], v[132:135], v[84:87]
    v_mfma_f32_16x16x32_bf16 v[88:91], v[40:43], v[136:139], v[88:91]
    v_mfma_f32_16x16x32_bf16 v[92:95], v[40:43], v[140:143], v[92:95]
    ds_read_b128 v[128:131], v7 offset:4096
    ds_read_b128 v[132:135], v7 offset:5120
    ds_read_b128 v[136:139], v7 offset:6144
    ds_read_b128 v[140:143], v7 offset:7168
    s_waitcnt lgkmcnt(4)
    v_mfma_f32_16x16x32_bf16 v[80:83], v[44:47], v[144:147], v[80:83]
    v_mfma_f32_16x16x32_bf16 v[84:87], v[44:47], v[148:151], v[84:87]
    v_mfma_f32_16x16x32_bf16 v[88:91], v[44:47], v[152:155], v[88:91]
    v_mfma_f32_16x16x32_bf16 v[92:95], v[44:47], v[156:159], v[92:95]
    ds_read_b128 v[144:147], v7 offset:8192
    ds_read_b128 v[148:151], v7 offset:9216
    ds_read_b128 v[152:155], v7 offset:10240
    ds_read_b128 v[156:159], v7 offset:11264
    s_waitcnt lgkmcnt(4)
    v_mfma_f32_16x16x32_bf16 v[80:83], v[48:51], v[128:131], v[80:83]
    v_mfma_f32_16x16x32_bf16 v[84:87], v[48:51], v[132:135], v[84:87]
    v_mfma_f32_16x16x32_bf16 v[88:91], v[48:51], v[136:139], v[88:91]
    v_mfma_f32_16x16x32_bf16 v[92:95], v[48:51], v[140:143], v[92:95]
    ds_read_b128 v[128:131], v7 offset:12288
    ds_read_b128 v[132:135], v7 offset:13312
    ds_read_b128 v[136:139], v7 offset:14336
    ds_read_b128 v[140:143], v7 offset:15360
    s_waitcnt lgkmcnt(4)
    v_mfma_f32_16x16x32_bf16 v[80:83], v[52:55], v[144:147], v[80:83]
    v_mfma_f32_16x16x32_bf16 v[84:87], v[52:55], v[148:151], v[84:87]
    v_mfma_f32_16x16x32_bf16 v[88:91], v[52:55], v[152:155], v[88:91]
    v_mfma_f32_16x16x32_bf16 v[92:95], v[52:55], v[156:159], v[92:95]
    ds_read_b128 v[144:147], v7 offset:16384
    ds_read_b128 v[148:151], v7 offset:17408
    ds_read_b128 v[152:155], v7 offset:18432
    ds_read_b128 v[156:159], v7 offset:19456
    s_waitcnt lgkmcnt(4)
    v_mfma_f32_16x16x32_bf16 v[80:83], v[56:59], v[128:131], v[80:83]
    v_mfma_f32_16x16x32_bf16 v[84:87], v[56:59], v[132:135], v[84:87]
    v_mfma_f32_16x16x32_bf16 v[88:91], v[56:59], v[136:139], v[88:91]
    v_mfma_f32_16x16x32_bf16 v[92:95], v[56:59], v[140:143], v[92:95]
    ds_read_b128 v[128:131], v7 offset:20480
    ds_read_b128 v[132:135], v7 offset:21504
    ds_read_b128 v[136:139], v7 offset:22528
    ds_read_b128 v[140:143], v7 offset:23552
    s_waitcnt lgkmcnt(4)
    v_mfma_f32_16x16x32_bf16 v[80:83], v[60:63], v[144:147], v[80:83]
    v_mfma_f32_16x16x32_bf16 v[84:87], v[60:63], v[148:151], v[84:87]
    v_mfma_f32_16x16x32_bf16 v[88:91], v[60:63], v[152:155], v[88:91]
    v_mfma_f32_16x16x32_bf16 v[92:95], v[60:63], v[156:159], v[92:95]
    ds_read_b128 v[144:147], v7 offset:24576
    ds_read_b128 v[148:151], v7 offset:25600
    ds_read_b128 v[152:155], v7 offset:26624
    ds_read_b128 v[156:159], v7 offset:27648
    s_waitcnt lgkmcnt(4)
    v_mfma_f32_16x16x32_bf16 v[80:83], v[64:67], v[128:131], v[80:83]
    v_mfma_f32_16x16x32_bf16 v[84:87], v[64:67], v[132:135], v[84:87]
    v_mfma_f32_16x16x32_bf16 v[88:91], v[64:67], v[136:139], v[88:91]
    v_mfma_f32_16x16x32_bf16 v[92:95], v[64:67], v[140:143], v[92:95]
    ds_read_b128 v[128:131], v7 offset:28672
    ds_read_b128 v[132:135], v7 offset:29696
    ds_read_b128 v[136:139], v7 offset:30720
    ds_read_b128 v[140:143], v7 offset:31744
    s_waitcnt lgkmcnt(4)
    v_mfma_f32_16x16x32_bf16 v[80:83], v[68:71], v[144:147], v[80:83]
    v_mfma_f32_16x16x32_bf16 v[84:87], v[68:71], v[148:151], v[84:87]
    v_mfma_f32_16x16x32_bf16 v[88:91], v[68:71], v[152:155], v[88:91]
    v_mfma_f32_16x16x32_bf16 v[92:95], v[68:71], v[156:159], v[92:95]
    ds_read_b128 v[144:147], v7 offset:32768
    ds_read_b128 v[148:151], v7 offset:33792
    ds_read_b128 v[152:155], v7 offset:34816
    ds_read_b128 v[156:159], v7 offset:35840
    s_waitcnt lgkmcnt(4)
    v_mfma_f32_16x16x32_bf16 v[80:83], v[72:75], v[128:131], v[80:83]
    v_mfma_f32_16x16x32_bf16 v[84:87], v[72:75], v[132:135], v[84:87]
    v_mfma_f32_16x16x32_bf16 v[88:91], v[72:75], v[136:139], v[88:91]
    v_mfma_f32_16x16x32_bf16 v[92:95], v[72:75], v[140:143], v[92:95]
    s_waitcnt lgkmcnt(0)
    v_mfma_f32_16x16x32_bf16 v[80:83], v[76:79], v[144:147], v[80:83]
    v_mfma_f32_16x16x32_bf16 v[84:87], v[76:79], v[148:151], v[84:87]
    v_mfma_f32_16x16x32_bf16 v[88:91], v[76:79], v[152:155], v[88:91]
    v_mfma_f32_16x16x32_bf16 v[92:95], v[76:79], v[156:159], v[92:95]
    s_nop 5
    v_permlane16_swap_b32 v80, v84
    v_permlane16_swap_b32 v81, v85
    v_permlane16_swap_b32 v82, v86
    v_permlane16_swap_b32 v83, v87
    v_lshlrev_b32 v132, 16, v100
    v_and_b32 v133, s30, v100
    v_add_f32 v80, v80, v132
    v_add_f32 v81, v81, v133
    v_cvt_pk_bf16_f32 v100, v80, v81
    v_lshlrev_b32 v132, 16, v101
    v_and_b32 v133, s30, v101
    v_add_f32 v82, v82, v132
    v_add_f32 v83, v83, v133
    v_cvt_pk_bf16_f32 v101, v82, v83
    v_lshlrev_b32 v132, 16, v102
    v_and_b32 v133, s30, v102
    v_add_f32 v84, v84, v132
    v_add_f32 v85, v85, v133
    v_cvt_pk_bf16_f32 v102, v84, v85
    v_lshlrev_b32 v132, 16, v103
    v_and_b32 v133, s30, v103
    v_add_f32 v86, v86, v132
    v_add_f32 v87, v87, v133
    v_cvt_pk_bf16_f32 v103, v86, v87
    buffer_store_dwordx4 v[100:103], v2, s[4:7], s29 offen offset:0 sc1
    ds_write_b128 v5, v[100:103] offset:0
    v_permlane16_swap_b32 v88, v92
    v_permlane16_swap_b32 v89, v93
    v_permlane16_swap_b32 v90, v94
    v_permlane16_swap_b32 v91, v95
    v_lshlrev_b32 v132, 16, v104
    v_and_b32 v133, s30, v104
    v_add_f32 v88, v88, v132
    v_add_f32 v89, v89, v133
    v_cvt_pk_bf16_f32 v104, v88, v89
    v_lshlrev_b32 v132, 16, v105
    v_and_b32 v133, s30, v105
    v_add_f32 v90, v90, v132
    v_add_f32 v91, v91, v133
    v_cvt_pk_bf16_f32 v105, v90, v91
    v_lshlrev_b32 v132, 16, v106
    v_and_b32 v133, s30, v106
    v_add_f32 v92, v92, v132
    v_add_f32 v93, v93, v133
    v_cvt_pk_bf16_f32 v106, v92, v93
    v_lshlrev_b32 v132, 16, v107
    v_and_b32 v133, s30, v107
    v_add_f32 v94, v94, v132
    v_add_f32 v95, v95, v133
    v_cvt_pk_bf16_f32 v107, v94, v95
    buffer_store_dwordx4 v[104:107], v2, s[4:7], s29 offen offset:2048 sc1
    ds_write_b128 v5, v[104:107] offset:512
B2_DONE:
    s_sub_u32 s27, s22, 2
    s_cmp_lt_u32 s27, 6
    s_cbranch_scc1 B2_ND
    s_waitcnt vmcnt(0)
B2_ND:
    s_waitcnt lgkmcnt(0)
    s_barrier
    s_cmp_lg_u32 s22, 0
    s_cbranch_scc1 Lf20
    s_add_u32 s27, s24, 3
    s_lshl_b32 s28, s20, 8
    s_lshl_b32 s29, s21, 2
    s_add_u32 s28, s28, s29
    v_mov_b32 v2, s27
    v_mov_b32 v3, 0
    s_mov_b64 exec, 1
    buffer_store_dword v2, v3, s[4:7], s28 offen sc1
    s_mov_b64 exec, -1
Lf20:
    s_mul_i32 s27, s21, 1152
    s_mul_i32 s28, s22, 96
    s_add_u32 s27, s27, s28
    v_lshrrev_b32 v2, 4, v0
    v_lshlrev_b32 v2, 3, v2
    buffer_load_dwordx2 v[160:161], v2, s[16:19], s27 offen offset:0
    buffer_load_dwordx2 v[162:163], v2, s[16:19], s27 offen offset:32
    buffer_load_dwordx2 v[164:165], v2, s[16:19], s27 offen offset:64
    s_cmp_lt_u32 s22, 2
    s_cbranch_scc1 C_PF
    s_cmp_lt_u32 s22, 12
    s_cbranch_scc1 C_NPF
C_PF:
    s_mov_b32 s26, s42
    buffer_load_dwordx4 v[8:11], v1, s[4:7], s26 offen
    buffer_load_dwordx4 v[12:15], v1, s[4:7], s26 offen offset:1024
    buffer_load_dwordx4 v[16:19], v1, s[4:7], s26 offen offset:2048
    buffer_load_dwordx4 v[20:23], v1, s[4:7], s26 offen offset:3072
    s_add_u32 s26, s26, 4096
    buffer_load_dwordx4 v[24:27], v1, s[4:7], s26 offen
    buffer_load_dwordx4 v[28:31], v1, s[4:7], s26 offen offset:1024
    buffer_load_dwordx4 v[32:35], v1, s[4:7], s26 offen offset:2048
    buffer_load_dwordx4 v[36:39], v1, s[4:7], s26 offen offset:3072
    s_add_u32 s26, s26, 4096
    buffer_load_dwordx4 v[40:43], v1, s[4:7], s26 offen
    buffer_load_dwordx4 v[44:47], v1, s[4:7], s26 offen offset:1024
    buffer_load_dwordx4 v[48:51], v1, s[4:7], s26 offen offset:2048
    buffer_load_dwordx4 v[52:55], v1, s[4:7], s26 offen offset:3072
    s_add_u32 s26, s26, 4096
    buffer_load_dwordx4 v[56:59], v1, s[4:7], s26 offen
    buffer_load_dwordx4 v[60:63], v1, s[4:7], s26 offen offset:1024
    buffer_load_dwordx4 v[64:67], v1, s[4:7], s26 offen offset:2048
    buffer_load_dwordx4 v[68:71], v1, s[4:7], s26 offen offset:3072
    s_add_u32 s26, s26, 4096
    buffer_load_dwordx4 v[72:75], v1, s[4:7], s26 offen
    buffer_load_dwordx4 v[76:79], v1, s[4:7], s26 offen offset:1024
C_NPF:
    s_cmp_lg_u32 s22, 8
    s_cbranch_scc1 Lp21
    s_cmp_lg_u32 s25, 0
    s_cbranch_scc1 Lp21
    s_mov_b32 s30, 0xff
    s_mov_b32 s31, 0
    v_lshlrev_b32 v2, 2, v0
    s_lshl_b32 s28, s20, 8
    s_bitset0_b32 s30, s21
    s_add_u32 s27, s24, 3
    s_mov_b32 s29, 400000
    s_mov_b64 exec, s[30:31]
Lpl22:
    buffer_load_dword v3, v2, s[4:7], s28 offen sc1
    s_waitcnt vmcnt(0)
    v_cmp_gt_u32 vcc, s27, v3
    s_nop 1
    s_cbranch_vccz Lpd23
    s_sub_u32 s29, s29, 1
    s_cbranch_scc0 Lpl22
    s_mov_b32 s25, 1
Lpd23:
    s_mov_b64 exec, -1
Lp21:
    s_barrier
    s_mul_i32 s29, s20, 73728
    s_add_u32 s29, s29, 28622848
    s_mul_i32 s96, s23, 2359296
    s_add_u32 s29, s29, s96
    s_lshr_b32 s27, s22, 2
    s_mul_i32 s27, s27, 24576
    s_and_b32 s28, s22, 3
    s_lshl_b32 s28, s28, 10
    s_add_u32 s27, s27, s28
    s_add_u32 s28, s27, s29
    buffer_load_dwordx4 v[128:131], v1, s[4:7], s28 offen sc1
    s_add_u32 s28, s28, 4096
    buffer_load_dwordx4 v[132:135], v1, s[4:7], s28 offen sc1
    s_add_u32 s28, s28, 4096
    buffer_load_dwordx4 v[136:139], v1, s[4:7], s28 offen sc1
    s_add_u32 s28, s28, 4096
    buffer_load_dwordx4 v[140:143], v1, s[4:7], s28 offen sc1
    s_add_u32 s28, s28, 4096
    buffer_load_dwordx4 v[144:147], v1, s[4:7], s28 offen sc1
    s_add_u32 s28, s28, 4096
    buffer_load_dwordx4 v[148:151], v1, s[4:7], s28 offen sc1
    s_sub_u32 s27, s22, 8
    s_cmp_lt_u32 s27, 4
    s_cbranch_scc1 C_LN2
    v_mov_b32 v156, 0x3f803f80
    v_mov_b32 v157, 0x3f803f80
    v_mov_b32 v158, 0x3f803f80
    v_mov_b32 v159, 0x3f803f80
    s_mov_b32 s27, 0xffff0000
    v_and_b32 v2, 15, v0
    s_and_b32 s28, s22, 3
    s_lshl_b32 s28, s28, 9
    s_add_u32 s28, s28, 156672
    v_lshl_add_u32 v2, v2, 5, s28
    s_lshr_b32 s28, s22, 2
    s_lshl_b32 s28, s28, 3
    v_add_u32 v3, s28, v2
    s_waitcnt vmcnt(5)
    v_mfma_f32_16x16x32_bf16 v[152:155], v[128:131], v[128:131], 0
    v_mfma_f32_16x16x32_bf16 v[4:7], v[156:159], v[128:131], 0
    v_lshlrev_b32 v80, 16, v128
    v_and_b32 v81, s27, v128
    v_lshlrev_b32 v82, 16, v129
    v_and_b32 v83, s27, v129
    v_lshlrev_b32 v84, 16, v130
    v_and_b32 v85, s27, v130
    v_lshlrev_b32 v86, 16, v131
    v_and_b32 v87, s27, v131
    s_waitcnt vmcnt(4)
    v_mfma_f32_16x16x32_bf16 v[152:155], v[132:135], v[132:135], v[152:155]
    v_mfma_f32_16x16x32_bf16 v[4:7], v[156:159], v[132:135], v[4:7]
    v_lshlrev_b32 v88, 16, v132
    v_and_b32 v89, s27, v132
    v_lshlrev_b32 v90, 16, v133
    v_and_b32 v91, s27, v133
    v_lshlrev_b32 v92, 16, v134
    v_and_b32 v93, s27, v134
    v_lshlrev_b32 v94, 16, v135
    v_and_b32 v95, s27, v135
    s_waitcnt vmcnt(3)
    v_mfma_f32_16x16x32_bf16 v[152:155], v[136:139], v[136:139], v[152:155]
    v_mfma_f32_16x16x32_bf16 v[4:7], v[156:159], v[136:139], v[4:7]
    s_waitcnt vmcnt(2)
    v_mfma_f32_16x16x32_bf16 v[152:155], v[140:143], v[140:143], v[152:155]
    v_mfma_f32_16x16x32_bf16 v[4:7], v[156:159], v[140:143], v[4:7]
    s_waitcnt vmcnt(1)
    v_mfma_f32_16x16x32_bf16 v[152:155], v[144:147], v[144:147], v[152:155]
    v_mfma_f32_16x16x32_bf16 v[4:7], v[156:159], v[144:147], v[4:7]
    s_waitcnt vmcnt(0)
    v_mfma_f32_16x16x32_bf16 v[152:155], v[148:151], v[148:151], v[152:155]
    v_mfma_f32_16x16x32_bf16 v[4:7], v[156:159], v[148:151], v[4:7]
    s_mov_b32 vcc_lo, 0xaaaaaaaa
    s_mov_b32 vcc_hi, 0xaaaaaaaa
    s_nop 4
    v_cndmask_b32 v152, v152, v153, vcc
    v_cndmask_b32 v154, v154, v155, vcc
    s_mov_b32 vcc_lo, 0xcccccccc
    s_mov_b32 vcc_hi, 0xcccccccc
    v_cndmask_b32 v5, v152, v154, vcc
    s_mov_b32 exec_lo, 0x00f0000f
    s_mov_b32 exec_hi, 0xf0000f00
    ds_write_b64 v3, v[4:5]
    s_mov_b64 exec, -1
    v_lshlrev_b32 v96, 16, v136
    v_and_b32 v97, s27, v136
    v_lshlrev_b32 v98, 16, v137
    v_and_b32 v99, s27, v137
    v_lshlrev_b32 v100, 16, v138
    v_and_b32 v101, s27, v138
    v_lshlrev_b32 v102, 16, v139
    v_and_b32 v103, s27, v139
    v_lshlrev_b32 v104, 16, v140
    v_and_b32 v105, s27, v140
    v_lshlrev_b32 v106, 16, v141
    v_and_b32 v107, s27, v141
    v_lshlrev_b32 v108, 16, v142
    v_and_b32 v109, s27, v142
    v_lshlrev_b32 v110, 16, v143
    v_and_b32 v111, s27, v143
    v_lshlrev_b32 v112, 16, v144
    v_and_b32 v113, s27, v144
    v_lshlrev_b32 v114, 16, v145
    v_and_b32 v115, s27, v145
    v_lshlrev_b32 v116, 16, v146
    v_and_b32 v117, s27, v146
    v_lshlrev_b32 v118, 16, v147
    v_and_b32 v119, s27, v147
    v_lshlrev_b32 v120, 16, v148
    v_and_b32 v121, s27, v148
    v_lshlrev_b32 v122, 16, v149
    v_and_b32 v123, s27, v149
    v_lshlrev_b32 v124, 16, v150
    v_and_b32 v125, s27, v150
    v_lshlrev_b32 v126, 16, v151
    v_and_b32 v127, s27, v151
    s_waitcnt lgkmcnt(0)
    s_barrier
    ds_read_b128 v[152:155], v2
    ds_read_b64 v[156:157], v2 offset:16
    s_lshr_b32 s27, s22, 2
    s_mul_i32 s27, s27, 24576
    s_and_b32 s28, s22, 3
    s_lshl_b32 s28, s28, 10
    s_add_u32 s27, s27, s28
    v_add_u32 v4, s27, v1
    s_mov_b32 s27, 0x3ae38e39
    s_mov_b32 s28, 0x3727c5ac
    s_waitcnt lgkmcnt(0)
    v_add_f32 v152, v152, v154
    v_add_f32 v153, v153, v155
    v_add_f32 v152, v152, v156
    v_add_f32 v153, v153, v157
    v_mul_f32 v152, s27, v152
    v_mul_f32 v153, s27, v153
    v_fma_f32 v153, -v152, v152, v153
    v_max_f32 v153, 0, v153
    v_add_f32 v154, s28, v153
    v_rsq_f32 v154, v154
    s_nop 0
    v_mul_f32 v155, v154, v154
    v_fma_f32 v155, v155, v153, s28
    v_rsq_f32 v155, v155
    s_nop 0
    v_mul_f32 v154, v154, v155
    v_mul_f32 v154, 0xbeeff558, v154
    v_mul_f32 v152, v152, v154
    v_pk_fma_f32 v[80:81], v[80:81], v[154:155], v[152:153] op_sel_hi:[1,0,0] neg_lo:[0,0,1] neg_hi:[0,0,1]
    v_pk_fma_f32 v[82:83], v[82:83], v[154:155], v[152:153] op_sel_hi:[1,0,0] neg_lo:[0,0,1] neg_hi:[0,0,1]
    v_pk_fma_f32 v[84:85], v[84:85], v[154:155], v[152:153] op_sel_hi:[1,0,0] neg_lo:[0,0,1] neg_hi:[0,0,1]
    v_pk_fma_f32 v[86:87], v[86:87], v[154:155], v[152:153] op_sel_hi:[1,0,0] neg_lo:[0,0,1] neg_hi:[0,0,1]
    v_cvt_pk_bf16_f32 v128, v80, v81
    v_cvt_pk_bf16_f32 v129, v82, v83
    v_cvt_pk_bf16_f32 v130, v84, v85
    v_cvt_pk_bf16_f32 v131, v86, v87
    ds_write_b128 v4, v[128:131] offset:0
    v_pk_fma_f32 v[88:89], v[88:89], v[154:155], v[152:153] op_sel_hi:[1,0,0] neg_lo:[0,0,1] neg_hi:[0,0,1]
    v_pk_fma_f32 v[90:91], v[90:91], v[154:155], v[152:153] op_sel_hi:[1,0,0] neg_lo:[0,0,1] neg_hi:[0,0,1]
    v_pk_fma_f32 v[92:93], v[92:93], v[154:155], v[152:153] op_sel_hi:[1,0,0] neg_lo:[0,0,1] neg_hi:[0,0,1]
    v_pk_fma_f32 v[94:95], v[94:95], v[154:155], v[152:153] op_sel_hi:[1,0,0] neg_lo:[0,0,1] neg_hi:[0,0,1]
    v_cvt_pk_bf16_f32 v132, v88, v89
    v_cvt_pk_bf16_f32 v133, v90, v91
    v_cvt_pk_bf16_f32 v134, v92, v93
    v_cvt_pk_bf16_f32 v135, v94, v95
    ds_write_b128 v4, v[132:135] offset:4096
    v_pk_fma_f32 v[96:97], v[96:97], v[154:155], v[152:153] op_sel_hi:[1,0,0] neg_lo:[0,0,1] neg_hi:[0,0,1]
    v_pk_fma_f32 v[98:99], v[98:99], v[154:155], v[152:153] op_sel_hi:[1,0,0] neg_lo:[0,0,1] neg_hi:[0,0,1]
    v_pk_fma_f32 v[100:101], v[100:101], v[154:155], v[152:153] op_sel_hi:[1,0,0] neg_lo:[0,0,1] neg_hi:[0,0,1]
    v_pk_fma_f32 v[102:103], v[102:103], v[154:155], v[152:153] op_sel_hi:[1,0,0] neg_lo:[0,0,1] neg_hi:[0,0,1]
    v_cvt_pk_bf16_f32 v136, v96, v97
    v_cvt_pk_bf16_f32 v137, v98, v99
    v_cvt_pk_bf16_f32 v138, v100, v101
    v_cvt_pk_bf16_f32 v139, v102, v103
    ds_write_b128 v4, v[136:139] offset:8192
    v_pk_fma_f32 v[104:105], v[104:105], v[154:155], v[152:153] op_sel_hi:[1,0,0] neg_lo:[0,0,1] neg_hi:[0,0,1]
    v_pk_fma_f32 v[106:107], v[106:107], v[154:155], v[152:153] op_sel_hi:[1,0,0] neg_lo:[0,0,1] neg_hi:[0,0,1]
    v_pk_fma_f32 v[108:109], v[108:109], v[154:155], v[152:153] op_sel_hi:[1,0,0] neg_lo:[0,0,1] neg_hi:[0,0,1]
    v_pk_fma_f32 v[110:111], v[110:111], v[154:155], v[152:153] op_sel_hi:[1,0,0] neg_lo:[0,0,1] neg_hi:[0,0,1]
    v_cvt_pk_bf16_f32 v140, v104, v105
    v_cvt_pk_bf16_f32 v141, v106, v107
    v_cvt_pk_bf16_f32 v142, v108, v109
    v_cvt_pk_bf16_f32 v143, v110, v111
    ds_write_b128 v4, v[140:143] offset:12288
    v_pk_fma_f32 v[112:113], v[112:113], v[154:155], v[152:153] op_sel_hi:[1,0,0] neg_lo:[0,0,1] neg_hi:[0,0,1]
    v_pk_fma_f32 v[114:115], v[114:115], v[154:155], v[152:153] op_sel_hi:[1,0,0] neg_lo:[0,0,1] neg_hi:[0,0,1]
    v_pk_fma_f32 v[116:117], v[116:117], v[154:155], v[152:153] op_sel_hi:[1,0,0] neg_lo:[0,0,1] neg_hi:[0,0,1]
    v_pk_fma_f32 v[118:119], v[118:119], v[154:155], v[152:153] op_sel_hi:[1,0,0] neg_lo:[0,0,1] neg_hi:[0,0,1]
    v_cvt_pk_bf16_f32 v144, v112, v113
    v_cvt_pk_bf16_f32 v145, v114, v115
    v_cvt_pk_bf16_f32 v146, v116, v117
    v_cvt_pk_bf16_f32 v147, v118, v119
    ds_write_b128 v4, v[144:147] offset:16384
    v_pk_fma_f32 v[120:121], v[120:121], v[154:155], v[152:153] op_sel_hi:[1,0,0] neg_lo:[0,0,1] neg_hi:[0,0,1]
    v_pk_fma_f32 v[122:123], v[122:123], v[154:155], v[152:153] op_sel_hi:[1,0,0] neg_lo:[0,0,1] neg_hi:[0,0,1]
    v_pk_fma_f32 v[124:125], v[124:125], v[154:155], v[152:153] op_sel_hi:[1,0,0] neg_lo:[0,0,1] neg_hi:[0,0,1]
    v_pk_fma_f32 v[126:127], v[126:127], v[154:155], v[152:153] op_sel_hi:[1,0,0] neg_lo:[0,0,1] neg_hi:[0,0,1]
    v_cvt_pk_bf16_f32 v148, v120, v121
    v_cvt_pk_bf16_f32 v149, v122, v123
    v_cvt_pk_bf16_f32 v150, v124, v125
    v_cvt_pk_bf16_f32 v151, v126, v127
    ds_write_b128 v4, v[148:151] offset:20480
    s_branch C_LN3
C_LN2:
    v_mov_b32 v156, 0x3f803f80
    v_mov_b32 v157, 0x3f803f80
    v_mov_b32 v158, 0x3f803f80
    v_mov_b32 v159, 0x3f803f80
    s_mov_b32 s27, 0xffff0000
    v_and_b32 v2, 15, v0
    s_and_b32 s28, s22, 3
    s_lshl_b32 s28, s28, 9
    s_add_u32 s28, s28, 156672
    v_lshl_add_u32 v2, v2, 5, s28
    s_lshr_b32 s28, s22, 2
    s_lshl_b32 s28, s28, 3
    v_add_u32 v3, s28, v2
    s_waitcnt vmcnt(5)
    v_mfma_f32_16x16x32_bf16 v[152:155], v[128:131], v[128:131], 0
    v_mfma_f32_16x16x32_bf16 v[4:7], v[156:159], v[128:131], 0
    v_lshlrev_b32 v80, 16, v128
    v_and_b32 v81, s27, v128
    v_lshlrev_b32 v82, 16, v129
    v_and_b32 v83, s27, v129
    v_lshlrev_b32 v84, 16, v130
    v_and_b32 v85, s27, v130
    v_lshlrev_b32 v86, 16, v131
    v_and_b32 v87, s27, v131
    s_mov_b32 s26, s42
    buffer_load_dwordx4 v[8:11], v1, s[4:7], s26 offen
    buffer_load_dwordx4 v[12:15], v1, s[4:7], s26 offen offset:1024
    s_waitcnt vmcnt(6)
    v_mfma_f32_16x16x32_bf16 v[152:155], v[132:135], v[132:135], v[152:155]
    v_mfma_f32_16x16x32_bf16 v[4:7], v[156:159], v[132:135], v[4:7]
    v_lshlrev_b32 v88, 16, v132
    v_and_b32 v89, s27, v132
    v_lshlrev_b32 v90, 16, v133
    v_and_b32 v91, s27, v133
    v_lshlrev_b32 v92, 16, v134
    v_and_b32 v93, s27, v134
    v_lshlrev_b32 v94, 16, v135
    v_and_b32 v95, s27, v135
    buffer_load_dwordx4 v[16:19], v1, s[4:7], s26 offen offset:2048
    buffer_load_dwordx4 v[20:23], v1, s[4:7], s26 offen offset:3072
    s_add_u32 s26, s26, 4096
    s_waitcnt vmcnt(7)
    v_mfma_f32_16x16x32_bf16 v[152:155], v[136:139], v[136:139], v[152:155]
    v_mfma_f32_16x16x32_bf16 v[4:7], v[156:159], v[136:139], v[4:7]
    buffer_load_dwordx4 v[24:27], v1, s[4:7], s26 offen
    buffer_load_dwordx4 v[28:31], v1, s[4:7], s26 offen offset:1024
    s_waitcnt vmcnt(8)
    v_mfma_f32_16x16x32_bf16 v[152:155], v[140:143], v[140:143], v[152:155]
    v_mfma_f32_16x16x32_bf16 v[4:7], v[156:159], v[140:143], v[4:7]
    buffer_load_dwordx4 v[32:35], v1, s[4:7], s26 offen offset:2048
    buffer_load_dwordx4 v[36:39], v1, s[4:7], s26 offen offset:3072
    s_add_u32 s26, s26, 4096
    s_waitcnt vmcnt(9)
    v_mfma_f32_16x16x32_bf16 v[152:155], v[144:147], v[144:147], v[152:155]
    v_mfma_f32_16x16x32_bf16 v[4:7], v[156:159], v[144:147], v[4:7]
    buffer_load_dwordx4 v[40:43], v1, s[4:7], s26 offen
    buffer_load_dwordx4 v[44:47], v1, s[4:7], s26 offen offset:1024
    s_waitcnt vmcnt(10)
    v_mfma_f32_16x16x32_bf16 v[152:155], v[148:151], v[148:151], v[152:155]
    v_mfma_f32_16x16x32_bf16 v[4:7], v[156:159], v[148:151], v[4:7]
    buffer_load_dwordx4 v[48:51], v1, s[4:7], s26 offen offset:2048
    buffer_load_dwordx4 v[52:55], v1, s[4:7], s26 offen offset:3072
    s_add_u32 s26, s26, 4096
    s_mov_b32 vcc_lo, 0xaaaaaaaa
    s_mov_b32 vcc_hi, 0xaaaaaaaa
    s_nop 1
    v_cndmask_b32 v152, v152, v153, vcc
    v_cndmask_b32 v154, v154, v155, vcc
    s_mov_b32 vcc_lo, 0xcccccccc
    s_mov_b32 vcc_hi, 0xcccccccc
    v_cndmask_b32 v5, v152, v154, vcc
    s_mov_b32 exec_lo, 0x00f0000f
    s_mov_b32 exec_hi, 0xf0000f00
    ds_write_b64 v3, v[4:5]
    s_mov_b64 exec, -1
    v_lshlrev_b32 v96, 16, v136
    v_and_b32 v97, s27, v136
    v_lshlrev_b32 v98, 16, v137
    v_and_b32 v99, s27, v137
    v_lshlrev_b32 v100, 16, v138
    v_and_b32 v101, s27, v138
    v_lshlrev_b32 v102, 16, v139
    v_and_b32 v103, s27, v139
    v_lshlrev_b32 v104, 16, v140
    v_and_b32 v105, s27, v140
    v_lshlrev_b32 v106, 16, v141
    v_and_b32 v107, s27, v141
    v_lshlrev_b32 v108, 16, v142
    v_and_b32 v109, s27, v142
    v_lshlrev_b32 v110, 16, v143
    v_and_b32 v111, s27, v143
    v_lshlrev_b32 v112, 16, v144
    v_and_b32 v113, s27, v144
    v_lshlrev_b32 v114, 16, v145
    v_and_b32 v115, s27, v145
    v_lshlrev_b32 v116, 16, v146
    v_and_b32 v117, s27, v146
    v_lshlrev_b32 v118, 16, v147
    v_and_b32 v119, s27, v147
    v_lshlrev_b32 v120, 16, v148
    v_and_b32 v121, s27, v148
    v_lshlrev_b32 v122, 16, v149
    v_and_b32 v123, s27, v149
    v_lshlrev_b32 v124, 16, v150
    v_and_b32 v125, s27, v150
    v_lshlrev_b32 v126, 16, v151
    v_and_b32 v127, s27, v151
    s_waitcnt lgkmcnt(0)
    s_barrier
    ds_read_b128 v[152:155], v2
    ds_read_b64 v[156:157], v2 offset:16
    s_lshr_b32 s27, s22, 2
    s_mul_i32 s27, s27, 24576
    s_and_b32 s28, s22, 3
    s_lshl_b32 s28, s28, 10
    s_add_u32 s27, s27, s28
    v_add_u32 v4, s27, v1
    s_mov_b32 s27, 0x3ae38e39
    s_mov_b32 s28, 0x3727c5ac
    s_waitcnt lgkmcnt(0)
    v_add_f32 v152, v152, v154
    v_add_f32 v153, v153, v155
    v_add_f32 v152, v152, v156
    v_add_f32 v153, v153, v157
    v_mul_f32 v152, s27, v152
    v_mul_f32 v153, s27, v153
    v_fma_f32 v153, -v152, v152, v153
    v_max_f32 v153, 0, v153
    v_add_f32 v154, s28, v153
    v_rsq_f32 v154, v154
    s_nop 0
    v_mul_f32 v155, v154, v154
    v_fma_f32 v155, v155, v153, s28
    v_rsq_f32 v155, v155
    s_nop 0
    v_mul_f32 v154, v154, v155
    v_mul_f32 v154, 0xbeeff558, v154
    v_mul_f32 v152, v152, v154
    v_pk_fma_f32 v[80:81], v[80:81], v[154:155], v[152:153] op_sel_hi:[1,0,0] neg_lo:[0,0,1] neg_hi:[0,0,1]
    v_pk_fma_f32 v[82:83], v[82:83], v[154:155], v[152:153] op_sel_hi:[1,0,0] neg_lo:[0,0,1] neg_hi:[0,0,1]
    v_pk_fma_f32 v[84:85], v[84:85], v[154:155], v[152:153] op_sel_hi:[1,0,0] neg_lo:[0,0,1] neg_hi:[0,0,1]
    v_pk_fma_f32 v[86:87], v[86:87], v[154:155], v[152:153] op_sel_hi:[1,0,0] neg_lo:[0,0,1] neg_hi:[0,0,1]
    v_cvt_pk_bf16_f32 v128, v80, v81
    v_cvt_pk_bf16_f32 v129, v82, v83
    v_cvt_pk_bf16_f32 v130, v84, v85
    v_cvt_pk_bf16_f32 v131, v86, v87
    ds_write_b128 v4, v[128:131] offset:0
    buffer_load_dwordx4 v[56:59], v1, s[4:7], s26 offen
    v_pk_fma_f32 v[88:89], v[88:89], v[154:155], v[152:153] op_sel_hi:[1,0,0] neg_lo:[0,0,1] neg_hi:[0,0,1]
    v_pk_fma_f32 v[90:91], v[90:91], v[154:155], v[152:153] op_sel_hi:[1,0,0] neg_lo:[0,0,1] neg_hi:[0,0,1]
    v_pk_fma_f32 v[92:93], v[92:93], v[154:155], v[152:153] op_sel_hi:[1,0,0] neg_lo:[0,0,1] neg_hi:[0,0,1]
    v_pk_fma_f32 v[94:95], v[94:95], v[154:155], v[152:153] op_sel_hi:[1,0,0] neg_lo:[0,0,1] neg_hi:[0,0,1]
    v_cvt_pk_bf16_f32 v132, v88, v89
    v_cvt_pk_bf16_f32 v133, v90, v91
    v_cvt_pk_bf16_f32 v134, v92, v93
    v_cvt_pk_bf16_f32 v135, v94, v95
    ds_write_b128 v4, v[132:135] offset:4096
    buffer_load_dwordx4 v[60:63], v1, s[4:7], s26 offen offset:1024
    v_pk_fma_f32 v[96:97], v[96:97], v[154:155], v[152:153] op_sel_hi:[1,0,0] neg_lo:[0,0,1] neg_hi:[0,0,1]
    v_pk_fma_f32 v[98:99], v[98:99], v[154:155], v[152:153] op_sel_hi:[1,0,0] neg_lo:[0,0,1] neg_hi:[0,0,1]
    v_pk_fma_f32 v[100:101], v[100:101], v[154:155], v[152:153] op_sel_hi:[1,0,0] neg_lo:[0,0,1] neg_hi:[0,0,1]
    v_pk_fma_f32 v[102:103], v[102:103], v[154:155], v[152:153] op_sel_hi:[1,0,0] neg_lo:[0,0,1] neg_hi:[0,0,1]
    v_cvt_pk_bf16_f32 v136, v96, v97
    v_cvt_pk_bf16_f32 v137, v98, v99
    v_cvt_pk_bf16_f32 v138, v100, v101
    v_cvt_pk_bf16_f32 v139, v102, v103
    ds_write_b128 v4, v[136:139] offset:8192
    buffer_load_dwordx4 v[64:67], v1, s[4:7], s26 offen offset:2048
    v_pk_fma_f32 v[104:105], v[104:105], v[154:155], v[152:153] op_sel_hi:[1,0,0] neg_lo:[0,0,1] neg_hi:[0,0,1]
    v_pk_fma_f32 v[106:107], v[106:107], v[154:155], v[152:153] op_sel_hi:[1,0,0] neg_lo:[0,0,1] neg_hi:[0,0,1]
    v_pk_fma_f32 v[108:109], v[108:109], v[154:155], v[152:153] op_sel_hi:[1,0,0] neg_lo:[0,0,1] neg_hi:[0,0,1]
    v_pk_fma_f32 v[110:111], v[110:111], v[154:155], v[152:153] op_sel_hi:[1,0,0] neg_lo:[0,0,1] neg_hi:[0,0,1]
    v_cvt_pk_bf16_f32 v140, v104, v105
    v_cvt_pk_bf16_f32 v141, v106, v107
    v_cvt_pk_bf16_f32 v142, v108, v109
    v_cvt_pk_bf16_f32 v143, v110, v111
    ds_write_b128 v4, v[140:143] offset:12288
    buffer_load_dwordx4 v[68:71], v1, s[4:7], s26 offen offset:3072
    s_add_u32 s26, s26, 4096
    v_pk_fma_f32 v[112:113], v[112:113], v[154:155], v[152:153] op_sel_hi:[1,0,0] neg_lo:[0,0,1] neg_hi:[0,0,1]
    v_pk_fma_f32 v[114:115], v[114:115], v[154:155], v[152:153] op_sel_hi:[1,0,0] neg_lo:[0,0,1] neg_hi:[0,0,1]
    v_pk_fma_f32 v[116:117], v[116:117], v[154:155], v[152:153] op_sel_hi:[1,0,0] neg_lo:[0,0,1] neg_hi:[0,0,1]
    v_pk_fma_f32 v[118:119], v[118:119], v[154:155], v[152:153] op_sel_hi:[1,0,0] neg_lo:[0,0,1] neg_hi:[0,0,1]
    v_cvt_pk_bf16_f32 v144, v112, v113
    v_cvt_pk_bf16_f32 v145, v114, v115
    v_cvt_pk_bf16_f32 v146, v116, v117
    v_cvt_pk_bf16_f32 v147, v118, v119
    ds_write_b128 v4, v[144:147] offset:16384
    buffer_load_dwordx4 v[72:75], v1, s[4:7], s26 offen
    v_pk_fma_f32 v[120:121], v[120:121], v[154:155], v[152:153] op_sel_hi:[1,0,0] neg_lo:[0,0,1] neg_hi:[0,0,1]
    v_pk_fma_f32 v[122:123], v[122:123], v[154:155], v[152:153] op_sel_hi:[1,0,0] neg_lo:[0,0,1] neg_hi:[0,0,1]
    v_pk_fma_f32 v[124:125], v[124:125], v[154:155], v[152:153] op_sel_hi:[1,0,0] neg_lo:[0,0,1] neg_hi:[0,0,1]
    v_pk_fma_f32 v[126:127], v[126:127], v[154:155], v[152:153] op_sel_hi:[1,0,0] neg_lo:[0,0,1] neg_hi:[0,0,1]
    v_cvt_pk_bf16_f32 v148, v120, v121
    v_cvt_pk_bf16_f32 v149, v122, v123
    v_cvt_pk_bf16_f32 v150, v124, v125
    v_cvt_pk_bf16_f32 v151, v126, v127
    ds_write_b128 v4, v[148:151] offset:20480
    buffer_load_dwordx4 v[76:79], v1, s[4:7], s26 offen offset:1024
C_LN3:
    s_mov_b32 s27, 0xffff0000
    v_lshlrev_b32 v80, 16, v160
    v_and_b32 v81, s27, v160
    v_lshlrev_b32 v82, 16, v161
    v_and_b32 v83, s27, v161
    v_mul_f32 v80, 0xbeeff558, v80
    v_mul_f32 v81, 0xbeeff558, v81
    v_mul_f32 v82, 0xbeeff558, v82
    v_mul_f32 v83, 0xbeeff558, v83
    v_lshlrev_b32 v96, 16, v162
    v_and_b32 v97, s27, v162
    v_lshlrev_b32 v98, 16, v163
    v_and_b32 v99, s27, v163
    v_mul_f32 v96, 0xbeeff558, v96
    v_mul_f32 v97, 0xbeeff558, v97
    v_mul_f32 v98, 0xbeeff558, v98
    v_mul_f32 v99, 0xbeeff558, v99
    v_lshlrev_b32 v112, 16, v164
    v_and_b32 v113, s27, v164
    v_lshlrev_b32 v114, 16, v165
    v_and_b32 v115, s27, v165
    v_mul_f32 v112, 0xbeeff558, v112
    v_mul_f32 v113, 0xbeeff558, v113
    v_mul_f32 v114, 0xbeeff558, v114
    v_mul_f32 v115, 0xbeeff558, v115
    v_add_u32 v6, 0, v1
    v_add_u32 v7, 36864, v6
    s_waitcnt lgkmcnt(0)
    s_barrier
    s_setprio 3
    ds_read_b128 v[128:131], v6 offset:0
    ds_read_b128 v[132:135], v6 offset:1024
    ds_read_b128 v[136:139], v6 offset:2048
    ds_read_b128 v[140:143], v6 offset:3072
    ds_read_b128 v[144:147], v6 offset:4096
    ds_read_b128 v[148:151], v6 offset:5120
    ds_read_b128 v[152:155], v6 offset:6144
    ds_read_b128 v[156:159], v6 offset:7168
    s_waitcnt vmcnt(17) lgkmcnt(4)
    v_mfma_f32_16x16x32_bf16 v[92:95], v[8:11], v[140:143], v[80:83]
    v_mfma_f32_16x16x32_bf16 v[88:91], v[8:11], v[136:139], v[80:83]
    v_mfma_f32_16x16x32_bf16 v[84:87], v[8:11], v[132:135], v[80:83]
    v_mfma_f32_16x16x32_bf16 v[80:83], v[8:11], v[128:131], v[80:83]
    buffer_load_dwordx4 v[8:11], v1, s[4:7], s26 offen offset:2048
    s_waitcnt vmcnt(17)
    v_mfma_f32_16x16x32_bf16 v[108:111], v[12:15], v[140:143], v[96:99]
    v_mfma_f32_16x16x32_bf16 v[104:107], v[12:15], v[136:139], v[96:99]
    v_mfma_f32_16x16x32_bf16 v[100:103], v[12:15], v[132:135], v[96:99]
    v_mfma_f32_16x16x32_bf16 v[96:99], v[12:15], v[128:131], v[96:99]
    buffer_load_dwordx4 v[12:15], v1, s[4:7], s26 offen offset:3072
    s_add_u32 s26, s26, 4096
    s_waitcnt vmcnt(17)
    v_mfma_f32_16x16x32_bf16 v[124:127], v[16:19], v[140:143], v[112:115]
    v_mfma_f32_16x16x32_bf16 v[120:123], v[16:19], v[136:139], v[112:115]
    v_mfma_f32_16x16x32_bf16 v[116:119], v[16:19], v[132:135], v[112:115]
    v_mfma_f32_16x16x32_bf16 v[112:115], v[16:19], v[128:131], v[112:115]
    buffer_load_dwordx4 v[16:19], v1, s[4:7], s26 offen
    ds_read_b128 v[128:131], v6 offset:8192
    ds_read_b128 v[132:135], v6 offset:9216
    ds_read_b128 v[136:139], v6 offset:10240
    ds_read_b128 v[140:143], v6 offset:11264
    s_waitcnt vmcnt(17) lgkmcnt(4)
    v_mfma_f32_16x16x32_bf16 v[80:83], v[20:23], v[144:147], v[80:83]
    v_mfma_f32_16x16x32_bf16 v[84:87], v[20:23], v[148:151], v[84:87]
    v_mfma_f32_16x16x32_bf16 v[88:91], v[20:23], v[152:155], v[88:91]
    v_mfma_f32_16x16x32_bf16 v[92:95], v[20:23], v[156:159], v[92:95]
    buffer_load_dwordx4 v[20:23], v1, s[4:7], s26 offen offset:1024
    s_waitcnt vmcnt(17)
    v_mfma_f32_16x16x32_bf16 v[96:99], v[24:27], v[144:147], v[96:99]
    v_mfma_f32_16x16x32_bf16 v[100:103], v[24:27], v[148:151], v[100:103]
    v_mfma_f32_16x16x32_bf16 v[104:107], v[24:27], v[152:155], v[104:107]
    v_mfma_f32_16x16x32_bf16 v[108:111], v[24:27], v[156:159], v[108:111]
    buffer_load_dwordx4 v[24:27], v1, s[4:7], s26 offen offset:2048
    s_waitcnt vmcnt(17)
    v_mfma_f32_16x16x32_bf16 v[112:115], v[28:31], v[144:147], v[112:115]
    v_mfma_f32_16x16x32_bf16 v[116:119], v[28:31], v[148:151], v[116:119]
    v_mfma_f32_16x16x32_bf16 v[120:123], v[28:31], v[152:155], v[120:123]
    v_mfma_f32_16x16x32_bf16 v[124:127], v[28:31], v[156:159], v[124:127]
    buffer_load_dwordx4 v[28:31], v1, s[4:7], s26 offen offset:3072
    s_add_u32 s26, s26, 4096
    ds_read_b128 v[144:147], v6 offset:12288
    ds_read_b128 v[148:151], v6 offset:13312
    ds_read_b128 v[152:155], v6 offset:14336
    ds_read_b128 v[156:159], v6 offset:15360
    s_waitcnt vmcnt(17) lgkmcnt(4)
    v_mfma_f32_16x16x32_bf16 v[80:83], v[32:35], v[128:131], v[80:83]
    v_mfma_f32_16x16x32_bf16 v[84:87], v[32:35], v[132:135], v[84:87]
    v_mfma_f32_16x16x32_bf16 v[88:91], v[32:35], v[136:139], v[88:91]
    v_mfma_f32_16x16x32_bf16 v[92:95], v[32:35], v[140:143], v[92:95]
    buffer_load_dwordx4 v[32:35], v1, s[4:7], s26 offen
    s_waitcnt vmcnt(17)
    v_mfma_f32_16x16x32_bf16 v[96:99], v[36:39], v[128:131], v[96:99]
    v_mfma_f32_16x16x32_bf16 v[100:103], v[36:39], v[132:135], v[100:103]
    v_mfma_f32_16x16x32_bf16 v[104:107], v[36:39], v[136:139], v[104:107]
    v_mfma_f32_16x16x32_bf16 v[108:111], v[36:39], v[140:143], v[108:111]
    buffer_load_dwordx4 v[36:39], v1, s[4:7], s26 offen offset:1024
    s_waitcnt vmcnt(17)
    v_mfma_f32_16x16x32_bf16 v[112:115], v[40:43], v[128:131], v[112:115]
    v_mfma_f32_16x16x32_bf16 v[116:119], v[40:43], v[132:135], v[116:119]
    v_mfma_f32_16x16x32_bf16 v[120:123], v[40:43], v[136:139], v[120:123]
    v_mfma_f32_16x16x32_bf16 v[124:127], v[40:43], v[140:143], v[124:127]
    buffer_load_dwordx4 v[40:43], v1, s[4:7], s26 offen offset:2048
    ds_read_b128 v[128:131], v6 offset:16384
    ds_read_b128 v[132:135], v6 offset:17408
    ds_read_b128 v[136:139], v6 offset:18432
    ds_read_b128 v[140:143], v6 offset:19456
    s_waitcnt vmcnt(17) lgkmcnt(4)
    v_mfma_f32_16x16x32_bf16 v[80:83], v[44:47], v[144:147], v[80:83]
    v_mfma_f32_16x16x32_bf16 v[84:87], v[44:47], v[148:151], v[84:87]
    v_mfma_f32_16x16x32_bf16 v[88:91], v[44:47], v[152:155], v[88:91]
    v_mfma_f32_16x16x32_bf16 v[92:95], v[44:47], v[156:159], v[92:95]
    buffer_load_dwordx4 v[44:47], v1, s[4:7], s26 offen offset:3072
    s_add_u32 s26, s26, 4096
    s_waitcnt vmcnt(17)
    v_mfma_f32_16x16x32_bf16 v[96:99], v[48:51], v[144:147], v[96:99]
    v_mfma_f32_16x16x32_bf16 v[100:103], v[48:51], v[148:151], v[100:103]
    v_mfma_f32_16x16x32_bf16 v[104:107], v[48:51], v[152:155], v[104:107]
    v_mfma_f32_16x16x32_bf16 v[108:111], v[48:51], v[156:159], v[108:111]
    buffer_load_dwordx4 v[48:51], v1, s[4:7], s26 offen
    s_waitcnt vmcnt(17)
    v_mfma_f32_16x16x32_bf16 v[112:115], v[52:55], v[144:147], v[112:115]
    v_mfma_f32_16x16x32_bf16 v[116:119], v[52:55], v[148:151], v[116:119]
    v_mfma_f32_16x16x32_bf16 v[120:123], v[52:55], v[152:155], v[120:123]
    v_mfma_f32_16x16x32_bf16 v[124:127], v[52:55], v[156:159], v[124:127]
    buffer_load_dwordx4 v[52:55], v1, s[4:7], s26 offen offset:1024
    ds_read_b128 v[144:147], v6 offset:20480
    ds_read_b128 v[148:151], v6 offset:21504
    ds_read_b128 v[152:155], v6 offset:22528
    ds_read_b128 v[156:159], v6 offset:23552
    s_waitcnt vmcnt(17) lgkmcnt(4)
    v_mfma_f32_16x16x32_bf16 v[80:83], v[56:59], v[128:131], v[80:83]
    v_mfma_f32_16x16x32_bf16 v[84:87], v[56:59], v[132:135], v[84:87]
    v_mfma_f32_16x16x32_bf16 v[88:91], v[56:59], v[136:139], v[88:91]
    v_mfma_f32_16x16x32_bf16 v[92:95], v[56:59], v[140:143], v[92:95]
    buffer_load_dwordx4 v[56:59], v1, s[4:7], s26 offen offset:2048
    s_waitcnt vmcnt(17)
    v_mfma_f32_16x16x32_bf16 v[96:99], v[60:63], v[128:131], v[96:99]
    v_mfma_f32_16x16x32_bf16 v[100:103], v[60:63], v[132:135], v[100:103]
    v_mfma_f32_16x16x32_bf16 v[104:107], v[60:63], v[136:139], v[104:107]
    v_mfma_f32_16x16x32_bf16 v[108:111], v[60:63], v[140:143], v[108:111]
    buffer_load_dwordx4 v[60:63], v1, s[4:7], s26 offen offset:3072
    s_add_u32 s26, s26, 4096
    s_waitcnt vmcnt(17)
    v_mfma_f32_16x16x32_bf16 v[112:115], v[64:67], v[128:131], v[112:115]
    v_mfma_f32_16x16x32_bf16 v[116:119], v[64:67], v[132:135], v[116:119]
    v_mfma_f32_16x16x32_bf16 v[120:123], v[64:67], v[136:139], v[120:123]
    v_mfma_f32_16x16x32_bf16 v[124:127], v[64:67], v[140:143], v[124:127]
    buffer_load_dwordx4 v[64:67], v1, s[4:7], s26 offen
    ds_read_b128 v[128:131], v6 offset:24576
    ds_read_b128 v[132:135], v6 offset:25600
    ds_read_b128 v[136:139], v6 offset:26624
    ds_read_b128 v[140:143], v6 offset:27648
    s_waitcnt vmcnt(17) lgkmcnt(4)
    v_mfma_f32_16x16x32_bf16 v[80:83], v[68:71], v[144:147], v[80:83]
    v_mfma_f32_16x16x32_bf16 v[84:87], v[68:71], v[148:151], v[84:87]
    v_mfma_f32_16x16x32_bf16 v[88:91], v[68:71], v[152:155], v[88:91]
    v_mfma_f32_16x16x32_bf16 v[92:95], v[68:71], v[156:159], v[92:95]
    buffer_load_dwordx4 v[68:71], v1, s[4:7], s26 offen offset:1024
    s_waitcnt vmcnt(17)
    v_mfma_f32_16x16x32_bf16 v[96:99], v[72:75], v[144:147], v[96:99]
    v_mfma_f32_16x16x32_bf16 v[100:103], v[72:75], v[148:151], v[100:103]
    v_mfma_f32_16x16x32_bf16 v[104:107], v[72:75], v[152:155], v[104:107]
    v_mfma_f32_16x16x32_bf16 v[108:111], v[72:75], v[156:159], v[108:111]
    buffer_load_dwordx4 v[72:75], v1, s[4:7], s26 offen offset:2048
    s_waitcnt vmcnt(17)
    v_mfma_f32_16x16x32_bf16 v[112:115], v[76:79], v[144:147], v[112:115]
    v_mfma_f32_16x16x32_bf16 v[116:119], v[76:79], v[148:151], v[116:119]
    v_mfma_f32_16x16x32_bf16 v[120:123], v[76:79], v[152:155], v[120:123]
    v_mfma_f32_16x16x32_bf16 v[124:127], v[76:79], v[156:159], v[124:127]
    buffer_load_dwordx4 v[76:79], v1, s[4:7], s26 offen offset:3072
    s_add_u32 s26, s26, 4096
    ds_read_b128 v[144:147], v6 offset:28672
    ds_read_b128 v[148:151], v6 offset:29696
    ds_read_b128 v[152:155], v6 offset:30720
    ds_read_b128 v[156:159], v6 offset:31744
    s_waitcnt vmcnt(17) lgkmcnt(4)
    v_mfma_f32_16x16x32_bf16 v[80:83], v[8:11], v[128:131], v[80:83]
    v_mfma_f32_16x16x32_bf16 v[84:87], v[8:11], v[132:135], v[84:87]
    v_mfma_f32_16x16x32_bf16 v[88:91], v[8:11], v[136:139], v[88:91]
    v_mfma_f32_16x16x32_bf16 v[92:95], v[8:11], v[140:143], v[92:95]
    buffer_load_dwordx4 v[8:11], v1, s[4:7], s26 offen
    s_waitcnt vmcnt(17)
    v_mfma_f32_16x16x32_bf16 v[96:99], v[12:15], v[128:131], v[96:99]
    v_mfma_f32_16x16x32_bf16 v[100:103], v[12:15], v[132:135], v[100:103]
    v_mfma_f32_16x16x32_bf16 v[104:107], v[12:15], v[136:139], v[104:107]
    v_mfma_f32_16x16x32_bf16 v[108:111], v[12:15], v[140:143], v[108:111]
    buffer_load_dwordx4 v[12:15], v1, s[4:7], s26 offen offset:1024
    s_waitcnt vmcnt(17)
    v_mfma_f32_16x16x32_bf16 v[112:115], v[16:19], v[128:131], v[112:115]
    v_mfma_f32_16x16x32_bf16 v[116:119], v[16:19], v[132:135], v[116:119]
    v_mfma_f32_16x16x32_bf16 v[120:123], v[16:19], v[136:139], v[120:123]
    v_mfma_f32_16x16x32_bf16 v[124:127], v[16:19], v[140:143], v[124:127]
    buffer_load_dwordx4 v[16:19], v1, s[4:7], s26 offen offset:2048
    ds_read_b128 v[128:131], v6 offset:32768
    ds_read_b128 v[132:135], v6 offset:33792
    ds_read_b128 v[136:139], v6 offset:34816
    ds_read_b128 v[140:143], v6 offset:35840
    s_waitcnt vmcnt(17) lgkmcnt(4)
    v_mfma_f32_16x16x32_bf16 v[80:83], v[20:23], v[144:147], v[80:83]
    v_mfma_f32_16x16x32_bf16 v[84:87], v[20:23], v[148:151], v[84:87]
    v_mfma_f32_16x16x32_bf16 v[88:91], v[20:23], v[152:155], v[88:91]
    v_mfma_f32_16x16x32_bf16 v[92:95], v[20:23], v[156:159], v[92:95]
    buffer_load_dwordx4 v[20:23], v1, s[4:7], s26 offen offset:3072
    s_add_u32 s26, s26, 4096
    s_waitcnt vmcnt(17)
    v_mfma_f32_16x16x32_bf16 v[96:99], v[24:27], v[144:147], v[96:99]
    v_mfma_f32_16x16x32_bf16 v[100:103], v[24:27], v[148:151], v[100:103]
    v_mfma_f32_16x16x32_bf16 v[104:107], v[24:27], v[152:155], v[104:107]
    v_mfma_f32_16x16x32_bf16 v[108:111], v[24:27], v[156:159], v[108:111]
    buffer_load_dwordx4 v[24:27], v1, s[4:7], s26 offen
    s_waitcnt vmcnt(17)
    v_mfma_f32_16x16x32_bf16 v[112:115], v[28:31], v[144:147], v[112:115]
    v_mfma_f32_16x16x32_bf16 v[116:119], v[28:31], v[148:151], v[116:119]
    v_mfma_f32_16x16x32_bf16 v[120:123], v[28:31], v[152:155], v[120:123]
    v_mfma_f32_16x16x32_bf16 v[124:127], v[28:31], v[156:159], v[124:127]
    buffer_load_dwordx4 v[28:31], v1, s[4:7], s26 offen offset:1024
    ds_read_b128 v[144:147], v7 offset:0
    ds_read_b128 v[148:151], v7 offset:1024
    ds_read_b128 v[152:155], v7 offset:2048
    ds_read_b128 v[156:159], v7 offset:3072
    s_waitcnt vmcnt(17) lgkmcnt(4)
    v_mfma_f32_16x16x32_bf16 v[80:83], v[32:35], v[128:131], v[80:83]
    v_mfma_f32_16x16x32_bf16 v[84:87], v[32:35], v[132:135], v[84:87]
    v_mfma_f32_16x16x32_bf16 v[88:91], v[32:35], v[136:139], v[88:91]
    v_mfma_f32_16x16x32_bf16 v[92:95], v[32:35], v[140:143], v[92:95]
    buffer_load_dwordx4 v[32:35], v1, s[4:7], s26 offen offset:2048
    s_waitcnt vmcnt(17)
    v_mfma_f32_16x16x32_bf16 v[96:99], v[36:39], v[128:131], v[96:99]
    v_mfma_f32_16x16x32_bf16 v[100:103], v[36:39], v[132:135], v[100:103]
    v_mfma_f32_16x16x32_bf16 v[104:107], v[36:39], v[136:139], v[104:107]
    v_mfma_f32_16x16x32_bf16 v[108:111], v[36:39], v[140:143], v[108:111]
    buffer_load_dwordx4 v[36:39], v1, s[4:7], s26 offen offset:3072
    s_add_u32 s26, s26, 4096
    s_waitcnt vmcnt(17)
    v_mfma_f32_16x16x32_bf16 v[112:115], v[40:43], v[128:131], v[112:115]
    v_mfma_f32_16x16x32_bf16 v[116:119], v[40:43], v[132:135], v[116:119]
    v_mfma_f32_16x16x32_bf16 v[120:123], v[40:43], v[136:139], v[120:123]
    v_mfma_f32_16x16x32_bf16 v[124:127], v[40:43], v[140:143], v[124:127]
    buffer_load_dwordx4 v[40:43], v1, s[4:7], s26 offen
    ds_read_b128 v[128:131], v7 offset:4096
    ds_read_b128 v[132:135], v7 offset:5120
    ds_read_b128 v[136:139], v7 offset:6144
    ds_read_b128 v[140:143], v7 offset:7168
    s_waitcnt vmcnt(17) lgkmcnt(4)
    v_mfma_f32_16x16x32_bf16 v[80:83], v[44:47], v[144:147], v[80:83]
    v_mfma_f32_16x16x32_bf16 v[84:87], v[44:47], v[148:151], v[84:87]
    v_mfma_f32_16x16x32_bf16 v[88:91], v[44:47], v[152:155], v[88:91]
    v_mfma_f32_16x16x32_bf16 v[92:95], v[44:47], v[156:159], v[92:95]
    buffer_load_dwordx4 v[44:47], v1, s[4:7], s26 offen offset:1024
    s_waitcnt vmcnt(17)
    v_mfma_f32_16x16x32_bf16 v[96:99], v[48:51], v[144:147], v[96:99]
    v_mfma_f32_16x16x32_bf16 v[100:103], v[48:51], v[148:151], v[100:103]
    v_mfma_f32_16x16x32_bf16 v[104:107], v[48:51], v[152:155], v[104:107]
    v_mfma_f32_16x16x32_bf16 v[108:111], v[48:51], v[156:159], v[108:111]
    buffer_load_dwordx4 v[48:51], v1, s[4:7], s26 offen offset:2048
    s_waitcnt vmcnt(17)
    v_mfma_f32_16x16x32_bf16 v[112:115], v[52:55], v[144:147], v[112:115]
    v_mfma_f32_16x16x32_bf16 v[116:119], v[52:55], v[148:151], v[116:119]
    v_mfma_f32_16x16x32_bf16 v[120:123], v[52:55], v[152:155], v[120:123]
    v_mfma_f32_16x16x32_bf16 v[124:127], v[52:55], v[156:159], v[124:127]
    buffer_load_dwordx4 v[52:55], v1, s[4:7], s26 offen offset:3072
    s_add_u32 s26, s26, 4096
    ds_read_b128 v[144:147], v7 offset:8192
    ds_read_b128 v[148:151], v7 offset:9216
    ds_read_b128 v[152:155], v7 offset:10240
    ds_read_b128 v[156:159], v7 offset:11264
    s_waitcnt vmcnt(17) lgkmcnt(4)
    v_mfma_f32_16x16x32_bf16 v[80:83], v[56:59], v[128:131], v[80:83]
    v_mfma_f32_16x16x32_bf16 v[84:87], v[56:59], v[132:135], v[84:87]
    v_mfma_f32_16x16x32_bf16 v[88:91], v[56:59], v[136:139], v[88:91]
    v_mfma_f32_16x16x32_bf16 v[92:95], v[56:59], v[140:143], v[92:95]
    buffer_load_dwordx4 v[56:59], v1, s[4:7], s26 offen
    s_waitcnt vmcnt(17)
    v_mfma_f32_16x16x32_bf16 v[96:99], v[60:63], v[128:131], v[96:99]
    v_mfma_f32_16x16x32_bf16 v[100:103], v[60:63], v[132:135], v[100:103]
    v_mfma_f32_16x16x32_bf16 v[104:107], v[60:63], v[136:139], v[104:107]
    v_mfma_f32_16x16x32_bf16 v[108:111], v[60:63], v[140:143], v[108:111]
    buffer_load_dwordx4 v[60:63], v1, s[4:7], s26 offen offset:1024
    s_waitcnt vmcnt(17)
    v_mfma_f32_16x16x32_bf16 v[112:115], v[64:67], v[128:131], v[112:115]
    v_mfma_f32_16x16x32_bf16 v[116:119], v[64:67], v[132:135], v[116:119]
    v_mfma_f32_16x16x32_bf16 v[120:123], v[64:67], v[136:139], v[120:123]
    v_mfma_f32_16x16x32_bf16 v[124:127], v[64:67], v[140:143], v[124:127]
    buffer_load_dwordx4 v[64:67], v1, s[4:7], s26 offen offset:2048
    ds_read_b128 v[128:131], v7 offset:12288
    ds_read_b128 v[132:135], v7 offset:13312
    ds_read_b128 v[136:139], v7 offset:14336
    ds_read_b128 v[140:143], v7 offset:15360
    s_waitcnt vmcnt(17) lgkmcnt(4)
    v_mfma_f32_16x16x32_bf16 v[80:83], v[68:71], v[144:147], v[80:83]
    v_mfma_f32_16x16x32_bf16 v[84:87], v[68:71], v[148:151], v[84:87]
    v_mfma_f32_16x16x32_bf16 v[88:91], v[68:71], v[152:155], v[88:91]
    v_mfma_f32_16x16x32_bf16 v[92:95], v[68:71], v[156:159], v[92:95]
    buffer_load_dwordx4 v[68:71], v1, s[4:7], s26 offen offset:3072
    s_add_u32 s26, s26, 4096
    s_waitcnt vmcnt(17)
    v_mfma_f32_16x16x32_bf16 v[96:99], v[72:75], v[144:147], v[96:99]
    v_mfma_f32_16x16x32_bf16 v[100:103], v[72:75], v[148:151], v[100:103]
    v_mfma_f32_16x16x32_bf16 v[104:107], v[72:75], v[152:155], v[104:107]
    v_mfma_f32_16x16x32_bf16 v[108:111], v[72:75], v[156:159], v[108:111]
    buffer_load_dwordx4 v[72:75], v1, s[4:7], s26 offen
    s_waitcnt vmcnt(17)
    v_mfma_f32_16x16x32_bf16 v[112:115], v[76:79], v[144:147], v[112:115]
    v_mfma_f32_16x16x32_bf16 v[116:119], v[76:79], v[148:151], v[116:119]
    v_mfma_f32_16x16x32_bf16 v[120:123], v[76:79], v[152:155], v[120:123]
    v_mfma_f32_16x16x32_bf16 v[124:127], v[76:79], v[156:159], v[124:127]
    buffer_load_dwordx4 v[76:79], v1, s[4:7], s26 offen offset:1024
    ds_read_b128 v[144:147], v7 offset:16384
    ds_read_b128 v[148:151], v7 offset:17408
    ds_read_b128 v[152:155], v7 offset:18432
    ds_read_b128 v[156:159], v7 offset:19456
    s_waitcnt vmcnt(17) lgkmcnt(4)
    v_mfma_f32_16x16x32_bf16 v[80:83], v[8:11], v[128:131], v[80:83]
    v_mfma_f32_16x16x32_bf16 v[84:87], v[8:11], v[132:135], v[84:87]
    v_mfma_f32_16x16x32_bf16 v[88:91], v[8:11], v[136:139], v[88:91]
    v_mfma_f32_16x16x32_bf16 v[92:95], v[8:11], v[140:143], v[92:95]
    buffer_load_dwordx4 v[8:11], v1, s[4:7], s26 offen offset:2048
    s_waitcnt vmcnt(17)
    v_mfma_f32_16x16x32_bf16 v[96:99], v[12:15], v[128:131], v[96:99]
    v_mfma_f32_16x16x32_bf16 v[100:103], v[12:15], v[132:135], v[100:103]
    v_mfma_f32_16x16x32_bf16 v[104:107], v[12:15], v[136:139], v[104:107]
    v_mfma_f32_16x16x32_bf16 v[108:111], v[12:15], v[140:143], v[108:111]
    buffer_load_dwordx4 v[12:15], v1, s[4:7], s26 offen offset:3072
    s_add_u32 s26, s26, 4096
    s_waitcnt vmcnt(17)
    v_mfma_f32_16x16x32_bf16 v[112:115], v[16:19], v[128:131], v[112:115]
    v_mfma_f32_16x16x32_bf16 v[116:119], v[16:19], v[132:135], v[116:119]
    v_mfma_f32_16x16x32_bf16 v[120:123], v[16:19], v[136:139], v[120:123]
    v_mfma_f32_16x16x32_bf16 v[124:127], v[16:19], v[140:143], v[124:127]
    buffer_load_dwordx4 v[16:19], v1, s[4:7], s26 offen
    ds_read_b128 v[128:131], v7 offset:20480
    ds_read_b128 v[132:135], v7 offset:21504
    ds_read_b128 v[136:139], v7 offset:22528
    ds_read_b128 v[140:143], v7 offset:23552
    s_waitcnt vmcnt(17) lgkmcnt(4)
    v_mfma_f32_16x16x32_bf16 v[80:83], v[20:23], v[144:147], v[80:83]
    v_mfma_f32_16x16x32_bf16 v[84:87], v[20:23], v[148:151], v[84:87]
    v_mfma_f32_16x16x32_bf16 v[88:91], v[20:23], v[152:155], v[88:91]
    v_mfma_f32_16x16x32_bf16 v[92:95], v[20:23], v[156:159], v[92:95]
    buffer_load_dwordx4 v[20:23], v1, s[4:7], s26 offen offset:1024
    s_waitcnt vmcnt(17)
    v_mfma_f32_16x16x32_bf16 v[96:99], v[24:27], v[144:147], v[96:99]
    v_mfma_f32_16x16x32_bf16 v[100:103], v[24:27], v[148:151], v[100:103]
    v_mfma_f32_16x16x32_bf16 v[104:107], v[24:27], v[152:155], v[104:107]
    v_mfma_f32_16x16x32_bf16 v[108:111], v[24:27], v[156:159], v[108:111]
    buffer_load_dwordx4 v[24:27], v1, s[4:7], s26 offen offset:2048
    s_waitcnt vmcnt(17)
    v_mfma_f32_16x16x32_bf16 v[112:115], v[28:31], v[144:147], v[112:115]
    v_mfma_f32_16x16x32_bf16 v[116:119], v[28:31], v[148:151], v[116:119]
    v_mfma_f32_16x16x32_bf16 v[120:123], v[28:31], v[152:155], v[120:123]
    v_mfma_f32_16x16x32_bf16 v[124:127], v[28:31], v[156:159], v[124:127]
    buffer_load_dwordx4 v[28:31], v1, s[4:7], s26 offen offset:3072
    s_add_u32 s26, s26, 4096
    ds_read_b128 v[144:147], v7 offset:24576
    ds_read_b128 v[148:151], v7 offset:25600
    ds_read_b128 v[152:155], v7 offset:26624
    ds_read_b128 v[156:159], v7 offset:27648
    s_waitcnt vmcnt(17) lgkmcnt(4)
    v_mfma_f32_16x16x32_bf16 v[80:83], v[32:35], v[128:131], v[80:83]
    v_mfma_f32_16x16x32_bf16 v[84:87], v[32:35], v[132:135], v[84:87]
    v_mfma_f32_16x16x32_bf16 v[88:91], v[32:35], v[136:139], v[88:91]
    v_mfma_f32_16x16x32_bf16 v[92:95], v[32:35], v[140:143], v[92:95]
    buffer_load_dwordx4 v[32:35], v1, s[4:7], s26 offen
    s_waitcnt vmcnt(17)
    v_mfma_f32_16x16x32_bf16 v[96:99], v[36:39], v[128:131], v[96:99]
    v_mfma_f32_16x16x32_bf16 v[100:103], v[36:39], v[132:135], v[100:103]
    v_mfma_f32_16x16x32_bf16 v[104:107], v[36:39], v[136:139], v[104:107]
    v_mfma_f32_16x16x32_bf16 v[108:111], v[36:39], v[140:143], v[108:111]
    buffer_load_dwordx4 v[36:39], v1, s[4:7], s26 offen offset:1024
    s_waitcnt vmcnt(17)
    v_mfma_f32_16x16x32_bf16 v[112:115], v[40:43], v[128:131], v[112:115]
    v_mfma_f32_16x16x32_bf16 v[116:119], v[40:43], v[132:135], v[116:119]
    v_mfma_f32_16x16x32_bf16 v[120:123], v[40:43], v[136:139], v[120:123]
    v_mfma_f32_16x16x32_bf16 v[124:127], v[40:43], v[140:143], v[124:127]
    buffer_load_dwordx4 v[40:43], v1, s[4:7], s26 offen offset:2048
    ds_read_b128 v[128:131], v7 offset:28672
    ds_read_b128 v[132:135], v7 offset:29696
    ds_read_b128 v[136:139], v7 offset:30720
    ds_read_b128 v[140:143], v7 offset:31744
    s_waitcnt vmcnt(17) lgkmcnt(4)
    v_mfma_f32_16x16x32_bf16 v[80:83], v[44:47], v[144:147], v[80:83]
    v_mfma_f32_16x16x32_bf16 v[84:87], v[44:47], v[148:151], v[84:87]
    v_mfma_f32_16x16x32_bf16 v[88:91], v[44:47], v[152:155], v[88:91]
    v_mfma_f32_16x16x32_bf16 v[92:95], v[44:47], v[156:159], v[92:95]
    buffer_load_dwordx4 v[44:47], v1, s[4:7], s26 offen offset:3072
    s_add_u32 s26, s26, 4096
    s_waitcnt vmcnt(17)
    v_mfma_f32_16x16x32_bf16 v[96:99], v[48:51], v[144:147], v[96:99]
    v_mfma_f32_16x16x32_bf16 v[100:103], v[48:51], v[148:151], v[100:103]
    v_mfma_f32_16x16x32_bf16 v[104:107], v[48:51], v[152:155], v[104:107]
    v_mfma_f32_16x16x32_bf16 v[108:111], v[48:51], v[156:159], v[108:111]
    buffer_load_dwordx4 v[48:51], v1, s[4:7], s26 offen
    s_waitcnt vmcnt(17)
    v_mfma_f32_16x16x32_bf16 v[112:115], v[52:55], v[144:147], v[112:115]
    v_mfma_f32_16x16x32_bf16 v[116:119], v[52:55], v[148:151], v[116:119]
    v_mfma_f32_16x16x32_bf16 v[120:123], v[52:55], v[152:155], v[120:123]
    v_mfma_f32_16x16x32_bf16 v[124:127], v[52:55], v[156:159], v[124:127]
    buffer_load_dwordx4 v[52:55], v1, s[4:7], s26 offen offset:1024
    ds_read_b128 v[144:147], v7 offset:32768
    ds_read_b128 v[148:151], v7 offset:33792
    ds_read_b128 v[152:155], v7 offset:34816
    ds_read_b128 v[156:159], v7 offset:35840
    s_waitcnt vmcnt(17) lgkmcnt(4)
    v_mfma_f32_16x16x32_bf16 v[80:83], v[56:59], v[128:131], v[80:83]
    v_mfma_f32_16x16x32_bf16 v[84:87], v[56:59], v[132:135], v[84:87]
    v_mfma_f32_16x16x32_bf16 v[88:91], v[56:59], v[136:139], v[88:91]
    v_mfma_f32_16x16x32_bf16 v[92:95], v[56:59], v[140:143], v[92:95]
    buffer_load_dwordx4 v[56:59], v1, s[4:7], s26 offen offset:2048
    s_waitcnt vmcnt(17)
    v_mfma_f32_16x16x32_bf16 v[96:99], v[60:63], v[128:131], v[96:99]
    v_mfma_f32_16x16x32_bf16 v[100:103], v[60:63], v[132:135], v[100:103]
    v_mfma_f32_16x16x32_bf16 v[104:107], v[60:63], v[136:139], v[104:107]
    v_mfma_f32_16x16x32_bf16 v[108:111], v[60:63], v[140:143], v[108:111]
    buffer_load_dwordx4 v[60:63], v1, s[4:7], s26 offen offset:3072
    s_add_u32 s26, s26, 4096
    s_waitcnt vmcnt(17)
    v_mfma_f32_16x16x32_bf16 v[112:115], v[64:67], v[128:131], v[112:115]
    v_mfma_f32_16x16x32_bf16 v[116:119], v[64:67], v[132:135], v[116:119]
    v_mfma_f32_16x16x32_bf16 v[120:123], v[64:67], v[136:139], v[120:123]
    v_mfma_f32_16x16x32_bf16 v[124:127], v[64:67], v[140:143], v[124:127]
    buffer_load_dwordx4 v[64:67], v1, s[4:7], s26 offen
    s_waitcnt vmcnt(17) lgkmcnt(0)
    v_mfma_f32_16x16x32_bf16 v[80:83], v[68:71], v[144:147], v[80:83]
    v_mfma_f32_16x16x32_bf16 v[84:87], v[68:71], v[148:151], v[84:87]
    v_mfma_f32_16x16x32_bf16 v[88:91], v[68:71], v[152:155], v[88:91]
    v_mfma_f32_16x16x32_bf16 v[92:95], v[68:71], v[156:159], v[92:95]
    buffer_load_dwordx4 v[68:71], v1, s[4:7], s26 offen offset:1024
    s_waitcnt vmcnt(17)
    v_mfma_f32_16x16x32_bf16 v[96:99], v[72:75], v[144:147], v[96:99]
    v_mfma_f32_16x16x32_bf16 v[100:103], v[72:75], v[148:151], v[100:103]
    v_mfma_f32_16x16x32_bf16 v[104:107], v[72:75], v[152:155], v[104:107]
    v_mfma_f32_16x16x32_bf16 v[108:111], v[72:75], v[156:159], v[108:111]
    buffer_load_dwordx4 v[72:75], v1, s[4:7], s26 offen offset:2048
    s_waitcnt vmcnt(17)
    v_mfma_f32_16x16x32_bf16 v[112:115], v[76:79], v[144:147], v[112:115]
    v_mfma_f32_16x16x32_bf16 v[116:119], v[76:79], v[148:151], v[116:119]
    v_mfma_f32_16x16x32_bf16 v[120:123], v[76:79], v[152:155], v[120:123]
    v_mfma_f32_16x16x32_bf16 v[124:127], v[76:79], v[156:159], v[124:127]
    buffer_load_dwordx4 v[76:79], v1, s[4:7], s26 offen offset:3072
    s_add_u32 s26, s26, 4096
    s_mov_b32 s61, 0x409d30fc
    v_mov_b32 v160, 0xc0135761
    v_bfe_u32 v3, v0, 4, 1
    v_lshlrev_b32 v2, 10, v3
    v_lshrrev_b32 v3, 5, v0
    v_lshl_add_u32 v2, v3, 8, v2
    v_and_b32 v3, 15, v0
    v_lshl_add_u32 v2, v3, 4, v2
    s_mul_i32 s27, s22, 3
    s_add_u32 s27, s27, 0
    s_lshr_b32 s28, s27, 1
    s_lshl_b32 s28, s28, 12
    s_and_b32 s27, s27, 1
    s_lshl_b32 s27, s27, 9
    s_add_u32 s27, s27, s28
    s_add_u32 s27, s27, 73728
    v_add_u32 v3, s27, v2
    s_mul_i32 s27, s22, 3
    s_add_u32 s27, s27, 1
    s_lshr_b32 s28, s27, 1
    s_lshl_b32 s28, s28, 12
    s_and_b32 s27, s27, 1
    s_lshl_b32 s27, s27, 9
    s_add_u32 s27, s27, s28
    s_add_u32 s27, s27, 73728
    v_add_u32 v4, s27, v2
    s_mul_i32 s27, s22, 3
    s_add_u32 s27, s27, 2
    s_lshr_b32 s28, s27, 1
    s_lshl_b32 s28, s28, 12
    s_and_b32 s27, s27, 1
    s_lshl_b32 s27, s27, 9
    s_add_u32 s27, s27, s28
    s_add_u32 s27, s27, 73728
    v_add_u32 v5, s27, v2
    v_fma_f32 v128, v80, v80, s61
    v_fma_f32 v129, v81, v81, s61
    v_fma_f32 v130, v82, v82, s61
    v_fma_f32 v131, v83, v83, s61
    v_fma_f32 v132, v84, v84, s61
    v_fma_f32 v133, v85, v85, s61
    v_fma_f32 v134, v86, v86, s61
    v_fma_f32 v135, v87, v87, s61
    v_mul_f32 v128, v128, v80
    v_mul_f32 v129, v129, v81
    v_mul_f32 v130, v130, v82
    v_mul_f32 v131, v131, v83
    v_mul_f32 v132, v132, v84
    v_mul_f32 v133, v133, v85
    v_mul_f32 v134, v134, v86
    v_mul_f32 v135, v135, v87
    v_exp_f32 v128, v128
    v_exp_f32 v129, v129
    v_exp_f32 v130, v130
    v_exp_f32 v131, v131
    v_exp_f32 v132, v132
    v_exp_f32 v133, v133
    v_exp_f32 v134, v134
    v_exp_f32 v135, v135
    v_add_f32 v128, 1.0, v128
    v_add_f32 v129, 1.0, v129
    v_add_f32 v130, 1.0, v130
    v_add_f32 v131, 1.0, v131
    v_add_f32 v132, 1.0, v132
    v_add_f32 v133, 1.0, v133
    v_add_f32 v134, 1.0, v134
    v_add_f32 v135, 1.0, v135
    v_rcp_f32 v128, v128
    v_rcp_f32 v129, v129
    v_rcp_f32 v130, v130
    v_rcp_f32 v131, v131
    v_rcp_f32 v132, v132
    v_rcp_f32 v133, v133
    v_rcp_f32 v134, v134
    v_rcp_f32 v135, v135
    v_mul_f32 v80, v80, v128
    v_mul_f32 v81, v81, v129
    v_mul_f32 v82, v82, v130
    v_mul_f32 v83, v83, v131
    v_mul_f32 v84, v84, v132
    v_mul_f32 v85, v85, v133
    v_mul_f32 v86, v86, v134
    v_mul_f32 v87, v87, v135
    v_cvt_pk_bf16_f32 v136, v80, v81
    v_cvt_pk_bf16_f32 v138, v84, v85
    v_cvt_pk_bf16_f32 v137, v82, v83
    v_cvt_pk_bf16_f32 v139, v86, v87
    v_permlane16_swap_b32 v136, v138
    s_nop 0
    v_permlane16_swap_b32 v137, v139
    ds_write_b128 v3, v[136:139] offset:0
    v_fma_f32 v128, v88, v88, s61
    v_fma_f32 v129, v89, v89, s61
    v_fma_f32 v130, v90, v90, s61
    v_fma_f32 v131, v91, v91, s61
    v_fma_f32 v132, v92, v92, s61
    v_fma_f32 v133, v93, v93, s61
    v_fma_f32 v134, v94, v94, s61
    v_fma_f32 v135, v95, v95, s61
    v_mul_f32 v128, v128, v88
    v_mul_f32 v129, v129, v89
    v_mul_f32 v130, v130, v90
    v_mul_f32 v131, v131, v91
    v_mul_f32 v132, v132, v92
    v_mul_f32 v133, v133, v93
    v_mul_f32 v134, v134, v94
    v_mul_f32 v135, v135, v95
    v_exp_f32 v128, v128
    v_exp_f32 v129, v129
    v_exp_f32 v130, v130
    v_exp_f32 v131, v131
    v_exp_f32 v132, v132
    v_exp_f32 v133, v133
    v_exp_f32 v134, v134
    v_exp_f32 v135, v135
    v_add_f32 v128, 1.0, v128
    v_add_f32 v129, 1.0, v129
    v_add_f32 v130, 1.0, v130
    v_add_f32 v131, 1.0, v131
    v_add_f32 v132, 1.0, v132
    v_add_f32 v133, 1.0, v133
    v_add_f32 v134, 1.0, v134
    v_add_f32 v135, 1.0, v135
    v_rcp_f32 v128, v128
    v_rcp_f32 v129, v129
    v_rcp_f32 v130, v130
    v_rcp_f32 v131, v131
    v_rcp_f32 v132, v132
    v_rcp_f32 v133, v133
    v_rcp_f32 v134, v134
    v_rcp_f32 v135, v135
    v_mul_f32 v88, v88, v128
    v_mul_f32 v89, v89, v129
    v_mul_f32 v90, v90, v130
    v_mul_f32 v91, v91, v131
    v_mul_f32 v92, v92, v132
    v_mul_f32 v93, v93, v133
    v_mul_f32 v94, v94, v134
    v_mul_f32 v95, v95, v135
    v_cvt_pk_bf16_f32 v140, v88, v89
    v_cvt_pk_bf16_f32 v142, v92, v93
    v_cvt_pk_bf16_f32 v141, v90, v91
    v_cvt_pk_bf16_f32 v143, v94, v95
    v_permlane16_swap_b32 v140, v142
    s_nop 0
    v_permlane16_swap_b32 v141, v143
    ds_write_b128 v3, v[140:143] offset:2048
    v_fma_f32 v128, v96, v96, s61
    v_fma_f32 v129, v97, v97, s61
    v_fma_f32 v130, v98, v98, s61
    v_fma_f32 v131, v99, v99, s61
    v_fma_f32 v132, v100, v100, s61
    v_fma_f32 v133, v101, v101, s61
    v_fma_f32 v134, v102, v102, s61
    v_fma_f32 v135, v103, v103, s61
    v_mul_f32 v128, v128, v96
    v_mul_f32 v129, v129, v97
    v_mul_f32 v130, v130, v98
    v_mul_f32 v131, v131, v99
    v_mul_f32 v132, v132, v100
    v_mul_f32 v133, v133, v101
    v_mul_f32 v134, v134, v102
    v_mul_f32 v135, v135, v103
    v_exp_f32 v128, v128
    v_exp_f32 v129, v129
    v_exp_f32 v130, v130
    v_exp_f32 v131, v131
    v_exp_f32 v132, v132
    v_exp_f32 v133, v133
    v_exp_f32 v134, v134
    v_exp_f32 v135, v135
    v_add_f32 v128, 1.0, v128
    v_add_f32 v129, 1.0, v129
    v_add_f32 v130, 1.0, v130
    v_add_f32 v131, 1.0, v131
    v_add_f32 v132, 1.0, v132
    v_add_f32 v133, 1.0, v133
    v_add_f32 v134, 1.0, v134
    v_add_f32 v135, 1.0, v135
    v_rcp_f32 v128, v128
    v_rcp_f32 v129, v129
    v_rcp_f32 v130, v130
    v_rcp_f32 v131, v131
    v_rcp_f32 v132, v132
    v_rcp_f32 v133, v133
    v_rcp_f32 v134, v134
    v_rcp_f32 v135, v135
    v_mul_f32 v96, v96, v128
    v_mul_f32 v97, v97, v129
    v_mul_f32 v98, v98, v130
    v_mul_f32 v99, v99, v131
    v_mul_f32 v100, v100, v132
    v_mul_f32 v101, v101, v133
    v_mul_f32 v102, v102, v134
    v_mul_f32 v103, v103, v135
    v_cvt_pk_bf16_f32 v144, v96, v97
    v_cvt_pk_bf16_f32 v146, v100, v101
    v_cvt_pk_bf16_f32 v145, v98, v99
    v_cvt_pk_bf16_f32 v147, v102, v103
    v_permlane16_swap_b32 v144, v146
    s_nop 0
    v_permlane16_swap_b32 v145, v147
    ds_write_b128 v4, v[144:147] offset:0
    v_fma_f32 v128, v104, v104, s61
    v_fma_f32 v129, v105, v105, s61
    v_fma_f32 v130, v106, v106, s61
    v_fma_f32 v131, v107, v107, s61
    v_fma_f32 v132, v108, v108, s61
    v_fma_f32 v133, v109, v109, s61
    v_fma_f32 v134, v110, v110, s61
    v_fma_f32 v135, v111, v111, s61
    v_mul_f32 v128, v128, v104
    v_mul_f32 v129, v129, v105
    v_mul_f32 v130, v130, v106
    v_mul_f32 v131, v131, v107
    v_mul_f32 v132, v132, v108
    v_mul_f32 v133, v133, v109
    v_mul_f32 v134, v134, v110
    v_mul_f32 v135, v135, v111
    v_exp_f32 v128, v128
    v_exp_f32 v129, v129
    v_exp_f32 v130, v130
    v_exp_f32 v131, v131
    v_exp_f32 v132, v132
    v_exp_f32 v133, v133
    v_exp_f32 v134, v134
    v_exp_f32 v135, v135
    v_add_f32 v128, 1.0, v128
    v_add_f32 v129, 1.0, v129
    v_add_f32 v130, 1.0, v130
    v_add_f32 v131, 1.0, v131
    v_add_f32 v132, 1.0, v132
    v_add_f32 v133, 1.0, v133
    v_add_f32 v134, 1.0, v134
    v_add_f32 v135, 1.0, v135
    v_rcp_f32 v128, v128
    v_rcp_f32 v129, v129
    v_rcp_f32 v130, v130
    v_rcp_f32 v131, v131
    v_rcp_f32 v132, v132
    v_rcp_f32 v133, v133
    v_rcp_f32 v134, v134
    v_rcp_f32 v135, v135
    v_mul_f32 v104, v104, v128
    v_mul_f32 v105, v105, v129
    v_mul_f32 v106, v106, v130
    v_mul_f32 v107, v107, v131
    v_mul_f32 v108, v108, v132
    v_mul_f32 v109, v109, v133
    v_mul_f32 v110, v110, v134
    v_mul_f32 v111, v111, v135
    v_cvt_pk_bf16_f32 v148, v104, v105
    v_cvt_pk_bf16_f32 v150, v108, v109
    v_cvt_pk_bf16_f32 v149, v106, v107
    v_cvt_pk_bf16_f32 v151, v110, v111
    v_permlane16_swap_b32 v148, v150
    s_nop 0
    v_permlane16_swap_b32 v149, v151
    ds_write_b128 v4, v[148:151] offset:2048
    v_fma_f32 v128, v112, v112, s61
    v_fma_f32 v129, v113, v113, s61
    v_fma_f32 v130, v114, v114, s61
    v_fma_f32 v131, v115, v115, s61
    v_fma_f32 v132, v116, v116, s61
    v_fma_f32 v133, v117, v117, s61
    v_fma_f32 v134, v118, v118, s61
    v_fma_f32 v135, v119, v119, s61
    v_mul_f32 v128, v128, v112
    v_mul_f32 v129, v129, v113
    v_mul_f32 v130, v130, v114
    v_mul_f32 v131, v131, v115
    v_mul_f32 v132, v132, v116
    v_mul_f32 v133, v133, v117
    v_mul_f32 v134, v134, v118
    v_mul_f32 v135, v135, v119
    v_exp_f32 v128, v128
    v_exp_f32 v129, v129
    v_exp_f32 v130, v130
    v_exp_f32 v131, v131
    v_exp_f32 v132, v132
    v_exp_f32 v133, v133
    v_exp_f32 v134, v134
    v_exp_f32 v135, v135
    v_add_f32 v128, 1.0, v128
    v_add_f32 v129, 1.0, v129
    v_add_f32 v130, 1.0, v130
    v_add_f32 v131, 1.0, v131
    v_add_f32 v132, 1.0, v132
    v_add_f32 v133, 1.0, v133
    v_add_f32 v134, 1.0, v134
    v_add_f32 v135, 1.0, v135
    v_rcp_f32 v128, v128
    v_rcp_f32 v129, v129
    v_rcp_f32 v130, v130
    v_rcp_f32 v131, v131
    v_rcp_f32 v132, v132
    v_rcp_f32 v133, v133
    v_rcp_f32 v134, v134
    v_rcp_f32 v135, v135
    v_mul_f32 v112, v112, v128
    v_mul_f32 v113, v113, v129
    v_mul_f32 v114, v114, v130
    v_mul_f32 v115, v115, v131
    v_mul_f32 v116, v116, v132
    v_mul_f32 v117, v117, v133
    v_mul_f32 v118, v118, v134
    v_mul_f32 v119, v119, v135
    v_cvt_pk_bf16_f32 v136, v112, v113
    v_cvt_pk_bf16_f32 v138, v116, v117
    v_cvt_pk_bf16_f32 v137, v114, v115
    v_cvt_pk_bf16_f32 v139, v118, v119
    v_permlane16_swap_b32 v136, v138
    s_nop 0
    v_permlane16_swap_b32 v137, v139
    ds_write_b128 v5, v[136:139] offset:0
    v_fma_f32 v128, v120, v120, s61
    v_fma_f32 v129, v121, v121, s61
    v_fma_f32 v130, v122, v122, s61
    v_fma_f32 v131, v123, v123, s61
    v_fma_f32 v132, v124, v124, s61
    v_fma_f32 v133, v125, v125, s61
    v_fma_f32 v134, v126, v126, s61
    v_fma_f32 v135, v127, v127, s61
    v_mul_f32 v128, v128, v120
    v_mul_f32 v129, v129, v121
    v_mul_f32 v130, v130, v122
    v_mul_f32 v131, v131, v123
    v_mul_f32 v132, v132, v124
    v_mul_f32 v133, v133, v125
    v_mul_f32 v134, v134, v126
    v_mul_f32 v135, v135, v127
    v_exp_f32 v128, v128
    v_exp_f32 v129, v129
    v_exp_f32 v130, v130
    v_exp_f32 v131, v131
    v_exp_f32 v132, v132
    v_exp_f32 v133, v133
    v_exp_f32 v134, v134
    v_exp_f32 v135, v135
    v_add_f32 v128, 1.0, v128
    v_add_f32 v129, 1.0, v129
    v_add_f32 v130, 1.0, v130
    v_add_f32 v131, 1.0, v131
    v_add_f32 v132, 1.0, v132
    v_add_f32 v133, 1.0, v133
    v_add_f32 v134, 1.0, v134
    v_add_f32 v135, 1.0, v135
    v_rcp_f32 v128, v128
    v_rcp_f32 v129, v129
    v_rcp_f32 v130, v130
    v_rcp_f32 v131, v131
    v_rcp_f32 v132, v132
    v_rcp_f32 v133, v133
    v_rcp_f32 v134, v134
    v_rcp_f32 v135, v135
    v_mul_f32 v120, v120, v128
    v_mul_f32 v121, v121, v129
    v_mul_f32 v122, v122, v130
    v_mul_f32 v123, v123, v131
    v_mul_f32 v124, v124, v132
    v_mul_f32 v125, v125, v133
    v_mul_f32 v126, v126, v134
    v_mul_f32 v127, v127, v135
    v_cvt_pk_bf16_f32 v140, v120, v121
    v_cvt_pk_bf16_f32 v142, v124, v125
    v_cvt_pk_bf16_f32 v141, v122, v123
    v_cvt_pk_bf16_f32 v143, v126, v127
    v_permlane16_swap_b32 v140, v142
    s_nop 0
    v_permlane16_swap_b32 v141, v143
    ds_write_b128 v5, v[140:143] offset:2048
    v_add_u32 v6, 73728, v1
    v_add_u32 v7, 36864, v6
    s_lshr_b32 s27, s22, 2
    s_lshl_b32 s27, s27, 5
    s_add_u32 s27, s27, 156696
    v_mov_b32 v2, s27
    v_mov_b32 v3, 1
    s_waitcnt lgkmcnt(0)
    s_mov_b64 exec, 1
    ds_add_u32 v2, v3
    s_mov_b64 exec, -1
    s_lshl_b32 s28, s23, 2
    s_add_u32 s28, s28, 4
    v_mov_b32 v2, 156696
    s_setprio 0
    s_mov_b32 s29, 0x400000
Lh24:
    ds_read_b32 v3, v2 offset:0
    s_waitcnt lgkmcnt(0)
    v_cmp_gt_u32 vcc, s28, v3
    s_nop 1
    s_cbranch_vccz Lhd25
    s_sub_u32 s29, s29, 1
    s_cbranch_scc0 Lh24
Lhd25:
    ds_read_b128 v[128:131], v6 offset:0
    ds_read_b128 v[132:135], v6 offset:1024
    ds_read_b128 v[136:139], v6 offset:2048
    ds_read_b128 v[140:143], v6 offset:3072
    ds_read_b128 v[144:147], v6 offset:4096
    ds_read_b128 v[148:151], v6 offset:5120
    ds_read_b128 v[152:155], v6 offset:6144
    ds_read_b128 v[156:159], v6 offset:7168
    s_waitcnt vmcnt(17) lgkmcnt(4)
    v_mfma_f32_16x16x32_bf16 v[80:83], v[8:11], v[128:131], 0
    v_mfma_f32_16x16x32_bf16 v[84:87], v[8:11], v[132:135], 0
    v_mfma_f32_16x16x32_bf16 v[88:91], v[8:11], v[136:139], 0
    v_mfma_f32_16x16x32_bf16 v[92:95], v[8:11], v[140:143], 0
    buffer_load_dwordx4 v[8:11], v1, s[4:7], s26 offen
    s_waitcnt vmcnt(17)
    v_mfma_f32_16x16x32_bf16 v[96:99], v[12:15], v[128:131], 0
    v_mfma_f32_16x16x32_bf16 v[100:103], v[12:15], v[132:135], 0
    v_mfma_f32_16x16x32_bf16 v[104:107], v[12:15], v[136:139], 0
    v_mfma_f32_16x16x32_bf16 v[108:111], v[12:15], v[140:143], 0
    buffer_load_dwordx4 v[12:15], v1, s[4:7], s26 offen offset:1024
    s_waitcnt vmcnt(17)
    v_mfma_f32_16x16x32_bf16 v[112:115], v[16:19], v[128:131], 0
    v_mfma_f32_16x16x32_bf16 v[116:119], v[16:19], v[132:135], 0
    v_mfma_f32_16x16x32_bf16 v[120:123], v[16:19], v[136:139], 0
    v_mfma_f32_16x16x32_bf16 v[124:127], v[16:19], v[140:143], 0
    buffer_load_dwordx4 v[16:19], v1, s[4:7], s26 offen offset:2048
    ds_read_b128 v[128:131], v6 offset:8192
    ds_read_b128 v[132:135], v6 offset:9216
    ds_read_b128 v[136:139], v6 offset:10240
    ds_read_b128 v[140:143], v6 offset:11264
    s_waitcnt vmcnt(17) lgkmcnt(4)
    v_mfma_f32_16x16x32_bf16 v[80:83], v[20:23], v[144:147], v[80:83]
    v_mfma_f32_16x16x32_bf16 v[84:87], v[20:23], v[148:151], v[84:87]
    v_mfma_f32_16x16x32_bf16 v[88:91], v[20:23], v[152:155], v[88:91]
    v_mfma_f32_16x16x32_bf16 v[92:95], v[20:23], v[156:159], v[92:95]
    buffer_load_dwordx4 v[20:23], v1, s[4:7], s26 offen offset:3072
    s_add_u32 s26, s26, 4096
    s_waitcnt vmcnt(17)
    v_mfma_f32_16x16x32_bf16 v[96:99], v[24:27], v[144:147], v[96:99]
    v_mfma_f32_16x16x32_bf16 v[100:103], v[24:27], v[148:151], v[100:103]
    v_mfma_f32_16x16x32_bf16 v[104:107], v[24:27], v[152:155], v[104:107]
    v_mfma_f32_16x16x32_bf16 v[108:111], v[24:27], v[156:159], v[108:111]
    buffer_load_dwordx4 v[24:27], v1, s[4:7], s26 offen
    s_waitcnt vmcnt(17)
    v_mfma_f32_16x16x32_bf16 v[112:115], v[28:31], v[144:147], v[112:115]
    v_mfma_f32_16x16x32_bf16 v[116:119], v[28:31], v[148:151], v[116:119]
    v_mfma_f32_16x16x32_bf16 v[120:123], v[28:31], v[152:155], v[120:123]
    v_mfma_f32_16x16x32_bf16 v[124:127], v[28:31], v[156:159], v[124:127]
    buffer_load_dwordx4 v[28:31], v1, s[4:7], s26 offen offset:1024
    ds_read_b128 v[144:147], v6 offset:12288
    ds_read_b128 v[148:151], v6 offset:13312
    ds_read_b128 v[152:155], v6 offset:14336
    ds_read_b128 v[156:159], v6 offset:15360
    s_waitcnt vmcnt(17) lgkmcnt(4)
    v_mfma_f32_16x16x32_bf16 v[80:83], v[32:35], v[128:131], v[80:83]
    v_mfma_f32_16x16x32_bf16 v[84:87], v[32:35], v[132:135], v[84:87]
    v_mfma_f32_16x16x32_bf16 v[88:91], v[32:35], v[136:139], v[88:91]
    v_mfma_f32_16x16x32_bf16 v[92:95], v[32:35], v[140:143], v[92:95]
    buffer_load_dwordx4 v[32:35], v1, s[4:7], s26 offen offset:2048
    s_waitcnt vmcnt(17)
    v_mfma_f32_16x16x32_bf16 v[96:99], v[36:39], v[128:131], v[96:99]
    v_mfma_f32_16x16x32_bf16 v[100:103], v[36:39], v[132:135], v[100:103]
    v_mfma_f32_16x16x32_bf16 v[104:107], v[36:39], v[136:139], v[104:107]
    v_mfma_f32_16x16x32_bf16 v[108:111], v[36:39], v[140:143], v[108:111]
    buffer_load_dwordx4 v[36:39], v1, s[4:7], s26 offen offset:3072
    s_add_u32 s26, s26, 4096
    s_waitcnt vmcnt(17)
    v_mfma_f32_16x16x32_bf16 v[112:115], v[40:43], v[128:131], v[112:115]
    v_mfma_f32_16x16x32_bf16 v[116:119], v[40:43], v[132:135], v[116:119]
    v_mfma_f32_16x16x32_bf16 v[120:123], v[40:43], v[136:139], v[120:123]
    v_mfma_f32_16x16x32_bf16 v[124:127], v[40:43], v[140:143], v[124:127]
    buffer_load_dwordx4 v[40:43], v1, s[4:7], s26 offen
    ds_read_b128 v[128:131], v6 offset:16384
    ds_read_b128 v[132:135], v6 offset:17408
    ds_read_b128 v[136:139], v6 offset:18432
    ds_read_b128 v[140:143], v6 offset:19456
    s_waitcnt vmcnt(17) lgkmcnt(4)
    v_mfma_f32_16x16x32_bf16 v[80:83], v[44:47], v[144:147], v[80:83]
    v_mfma_f32_16x16x32_bf16 v[84:87], v[44:47], v[148:151], v[84:87]
    v_mfma_f32_16x16x32_bf16 v[88:91], v[44:47], v[152:155], v[88:91]
    v_mfma_f32_16x16x32_bf16 v[92:95], v[44:47], v[156:159], v[92:95]
    buffer_load_dwordx4 v[44:47], v1, s[4:7], s26 offen offset:1024
    s_waitcnt vmcnt(17)
    v_mfma_f32_16x16x32_bf16 v[96:99], v[48:51], v[144:147], v[96:99]
    v_mfma_f32_16x16x32_bf16 v[100:103], v[48:51], v[148:151], v[100:103]
    v_mfma_f32_16x16x32_bf16 v[104:107], v[48:51], v[152:155], v[104:107]
    v_mfma_f32_16x16x32_bf16 v[108:111], v[48:51], v[156:159], v[108:111]
    buffer_load_dwordx4 v[48:51], v1, s[4:7], s26 offen offset:2048
    s_waitcnt vmcnt(17)
    v_mfma_f32_16x16x32_bf16 v[112:115], v[52:55], v[144:147], v[112:115]
    v_mfma_f32_16x16x32_bf16 v[116:119], v[52:55], v[148:151], v[116:119]
    v_mfma_f32_16x16x32_bf16 v[120:123], v[52:55], v[152:155], v[120:123]
    v_mfma_f32_16x16x32_bf16 v[124:127], v[52:55], v[156:159], v[124:127]
    buffer_load_dwordx4 v[52:55], v1, s[4:7], s26 offen offset:3072
    s_add_u32 s26, s26, 4096
    ds_read_b128 v[144:147], v6 offset:20480
    ds_read_b128 v[148:151], v6 offset:21504
    ds_read_b128 v[152:155], v6 offset:22528
    ds_read_b128 v[156:159], v6 offset:23552
    s_waitcnt vmcnt(17) lgkmcnt(4)
    v_mfma_f32_16x16x32_bf16 v[80:83], v[56:59], v[128:131], v[80:83]
    v_mfma_f32_16x16x32_bf16 v[84:87], v[56:59], v[132:135], v[84:87]
    v_mfma_f32_16x16x32_bf16 v[88:91], v[56:59], v[136:139], v[88:91]
    v_mfma_f32_16x16x32_bf16 v[92:95], v[56:59], v[140:143], v[92:95]
    buffer_load_dwordx4 v[56:59], v1, s[4:7], s26 offen
    s_waitcnt vmcnt(17)
    v_mfma_f32_16x16x32_bf16 v[96:99], v[60:63], v[128:131], v[96:99]
    v_mfma_f32_16x16x32_bf16 v[100:103], v[60:63], v[132:135], v[100:103]
    v_mfma_f32_16x16x32_bf16 v[104:107], v[60:63], v[136:139], v[104:107]
    v_mfma_f32_16x16x32_bf16 v[108:111], v[60:63], v[140:143], v[108:111]
    buffer_load_dwordx4 v[60:63], v1, s[4:7], s26 offen offset:1024
    s_waitcnt vmcnt(17)
    v_mfma_f32_16x16x32_bf16 v[112:115], v[64:67], v[128:131], v[112:115]
    v_mfma_f32_16x16x32_bf16 v[116:119], v[64:67], v[132:135], v[116:119]
    v_mfma_f32_16x16x32_bf16 v[120:123], v[64:67], v[136:139], v[120:123]
    v_mfma_f32_16x16x32_bf16 v[124:127], v[64:67], v[140:143], v[124:127]
    buffer_load_dwordx4 v[64:67], v1, s[4:7], s26 offen offset:2048
    s_mov_b32 s29, 0x400000
Lh26:
    ds_read_b32 v3, v2 offset:32
    s_waitcnt lgkmcnt(0)
    v_cmp_gt_u32 vcc, s28, v3
    s_nop 1
    s_cbranch_vccz Lhd27
    s_sub_u32 s29, s29, 1
    s_cbranch_scc0 Lh26
Lhd27:
    ds_read_b128 v[128:131], v6 offset:24576
    ds_read_b128 v[132:135], v6 offset:25600
    ds_read_b128 v[136:139], v6 offset:26624
    ds_read_b128 v[140:143], v6 offset:27648
    s_waitcnt vmcnt(17) lgkmcnt(4)
    v_mfma_f32_16x16x32_bf16 v[80:83], v[68:71], v[144:147], v[80:83]
    v_mfma_f32_16x16x32_bf16 v[84:87], v[68:71], v[148:151], v[84:87]
    v_mfma_f32_16x16x32_bf16 v[88:91], v[68:71], v[152:155], v[88:91]
    v_mfma_f32_16x16x32_bf16 v[92:95], v[68:71], v[156:159], v[92:95]
    buffer_load_dwordx4 v[68:71], v1, s[4:7], s26 offen offset:3072
    s_add_u32 s26, s26, 4096
    s_waitcnt vmcnt(17)
    v_mfma_f32_16x16x32_bf16 v[96:99], v[72:75], v[144:147], v[96:99]
    v_mfma_f32_16x16x32_bf16 v[100:103], v[72:75], v[148:151], v[100:103]
    v_mfma_f32_16x16x32_bf16 v[104:107], v[72:75], v[152:155], v[104:107]
    v_mfma_f32_16x16x32_bf16 v[108:111], v[72:75], v[156:159], v[108:111]
    buffer_load_dwordx4 v[72:75], v1, s[4:7], s26 offen
    s_waitcnt vmcnt(17)
    v_mfma_f32_16x16x32_bf16 v[112:115], v[76:79], v[144:147], v[112:115]
    v_mfma_f32_16x16x32_bf16 v[116:119], v[76:79], v[148:151], v[116:119]
    v_mfma_f32_16x16x32_bf16 v[120:123], v[76:79], v[152:155], v[120:123]
    v_mfma_f32_16x16x32_bf16 v[124:127], v[76:79], v[156:159], v[124:127]
    buffer_load_dwordx4 v[76:79], v1, s[4:7], s26 offen offset:1024
    ds_read_b128 v[144:147], v6 offset:28672
    ds_read_b128 v[148:151], v6 offset:29696
    ds_read_b128 v[152:155], v6 offset:30720
    ds_read_b128 v[156:159], v6 offset:31744
    s_waitcnt vmcnt(17) lgkmcnt(4)
    v_mfma_f32_16x16x32_bf16 v[80:83], v[8:11], v[128:131], v[80:83]
    v_mfma_f32_16x16x32_bf16 v[84:87], v[8:11], v[132:135], v[84:87]
    v_mfma_f32_16x16x32_bf16 v[88:91], v[8:11], v[136:139], v[88:91]
    v_mfma_f32_16x16x32_bf16 v[92:95], v[8:11], v[140:143], v[92:95]
    buffer_load_dwordx4 v[8:11], v1, s[4:7], s26 offen offset:2048
    s_waitcnt vmcnt(17)
    v_mfma_f32_16x16x32_bf16 v[96:99], v[12:15], v[128:131], v[96:99]
    v_mfma_f32_16x16x32_bf16 v[100:103], v[12:15], v[132:135], v[100:103]
    v_mfma_f32_16x16x32_bf16 v[104:107], v[12:15], v[136:139], v[104:107]
    v_mfma_f32_16x16x32_bf16 v[108:111], v[12:15], v[140:143], v[108:111]
    buffer_load_dwordx4 v[12:15], v1, s[4:7], s26 offen offset:3072
    s_add_u32 s26, s26, 4096
    s_waitcnt vmcnt(17)
    v_mfma_f32_16x16x32_bf16 v[112:115], v[16:19], v[128:131], v[112:115]
    v_mfma_f32_16x16x32_bf16 v[116:119], v[16:19], v[132:135], v[116:119]
    v_mfma_f32_16x16x32_bf16 v[120:123], v[16:19], v[136:139], v[120:123]
    v_mfma_f32_16x16x32_bf16 v[124:127], v[16:19], v[140:143], v[124:127]
    buffer_load_dwordx4 v[16:19], v1, s[4:7], s26 offen
    ds_read_b128 v[128:131], v6 offset:32768
    ds_read_b128 v[132:135], v6 offset:33792
    ds_read_b128 v[136:139], v6 offset:34816
    ds_read_b128 v[140:143], v6 offset:35840
    s_waitcnt vmcnt(17) lgkmcnt(4)
    v_mfma_f32_16x16x32_bf16 v[80:83], v[20:23], v[144:147], v[80:83]
    v_mfma_f32_16x16x32_bf16 v[84:87], v[20:23], v[148:151], v[84:87]
    v_mfma_f32_16x16x32_bf16 v[88:91], v[20:23], v[152:155], v[88:91]
    v_mfma_f32_16x16x32_bf16 v[92:95], v[20:23], v[156:159], v[92:95]
    buffer_load_dwordx4 v[20:23], v1, s[4:7], s26 offen offset:1024
    s_waitcnt vmcnt(17)
    v_mfma_f32_16x16x32_bf16 v[96:99], v[24:27], v[144:147], v[96:99]
    v_mfma_f32_16x16x32_bf16 v[100:103], v[24:27], v[148:151], v[100:103]
    v_mfma_f32_16x16x32_bf16 v[104:107], v[24:27], v[152:155], v[104:107]
    v_mfma_f32_16x16x32_bf16 v[108:111], v[24:27], v[156:159], v[108:111]
    buffer_load_dwordx4 v[24:27], v1, s[4:7], s26 offen offset:2048
    s_waitcnt vmcnt(17)
    v_mfma_f32_16x16x32_bf16 v[112:115], v[28:31], v[144:147], v[112:115]
    v_mfma_f32_16x16x32_bf16 v[116:119], v[28:31], v[148:151], v[116:119]
    v_mfma_f32_16x16x32_bf16 v[120:123], v[28:31], v[152:155], v[120:123]
    v_mfma_f32_16x16x32_bf16 v[124:127], v[28:31], v[156:159], v[124:127]
    buffer_load_dwordx4 v[28:31], v1, s[4:7], s26 offen offset:3072
    s_add_u32 s26, s26, 4096
    ds_read_b128 v[144:147], v7 offset:0
    ds_read_b128 v[148:151], v7 offset:1024
    ds_read_b128 v[152:155], v7 offset:2048
    ds_read_b128 v[156:159], v7 offset:3072
    s_waitcnt vmcnt(17) lgkmcnt(4)
    v_mfma_f32_16x16x32_bf16 v[80:83], v[32:35], v[128:131], v[80:83]
    v_mfma_f32_16x16x32_bf16 v[84:87], v[32:35], v[132:135], v[84:87]
    v_mfma_f32_16x16x32_bf16 v[88:91], v[32:35], v[136:139], v[88:91]
    v_mfma_f32_16x16x32_bf16 v[92:95], v[32:35], v[140:143], v[92:95]
    buffer_load_dwordx4 v[32:35], v1, s[4:7], s26 offen
    s_waitcnt vmcnt(17)
    v_mfma_f32_16x16x32_bf16 v[96:99], v[36:39], v[128:131], v[96:99]
    v_mfma_f32_16x16x32_bf16 v[100:103], v[36:39], v[132:135], v[100:103]
    v_mfma_f32_16x16x32_bf16 v[104:107], v[36:39], v[136:139], v[104:107]
    v_mfma_f32_16x16x32_bf16 v[108:111], v[36:39], v[140:143], v[108:111]
    buffer_load_dwordx4 v[36:39], v1, s[4:7], s26 offen offset:1024
    s_waitcnt vmcnt(17)
    v_mfma_f32_16x16x32_bf16 v[112:115], v[40:43], v[128:131], v[112:115]
    v_mfma_f32_16x16x32_bf16 v[116:119], v[40:43], v[132:135], v[116:119]
    v_mfma_f32_16x16x32_bf16 v[120:123], v[40:43], v[136:139], v[120:123]
    v_mfma_f32_16x16x32_bf16 v[124:127], v[40:43], v[140:143], v[124:127]
    buffer_load_dwordx4 v[40:43], v1, s[4:7], s26 offen offset:2048
    ds_read_b128 v[128:131], v7 offset:4096
    ds_read_b128 v[132:135], v7 offset:5120
    ds_read_b128 v[136:139], v7 offset:6144
    ds_read_b128 v[140:143], v7 offset:7168
    s_waitcnt vmcnt(17) lgkmcnt(4)
    v_mfma_f32_16x16x32_bf16 v[80:83], v[44:47], v[144:147], v[80:83]
    v_mfma_f32_16x16x32_bf16 v[84:87], v[44:47], v[148:151], v[84:87]
    v_mfma_f32_16x16x32_bf16 v[88:91], v[44:47], v[152:155], v[88:91]
    v_mfma_f32_16x16x32_bf16 v[92:95], v[44:47], v[156:159], v[92:95]
    buffer_load_dwordx4 v[44:47], v1, s[4:7], s26 offen offset:3072
    s_add_u32 s26, s26, 4096
    s_waitcnt vmcnt(17)
    v_mfma_f32_16x16x32_bf16 v[96:99], v[48:51], v[144:147], v[96:99]
    v_mfma_f32_16x16x32_bf16 v[100:103], v[48:51], v[148:151], v[100:103]
    v_mfma_f32_16x16x32_bf16 v[104:107], v[48:51], v[152:155], v[104:107]
    v_mfma_f32_16x16x32_bf16 v[108:111], v[48:51], v[156:159], v[108:111]
    buffer_load_dwordx4 v[48:51], v1, s[4:7], s26 offen
    s_waitcnt vmcnt(17)
    v_mfma_f32_16x16x32_bf16 v[112:115], v[52:55], v[144:147], v[112:115]
    v_mfma_f32_16x16x32_bf16 v[116:119], v[52:55], v[148:151], v[116:119]
    v_mfma_f32_16x16x32_bf16 v[120:123], v[52:55], v[152:155], v[120:123]
    v_mfma_f32_16x16x32_bf16 v[124:127], v[52:55], v[156:159], v[124:127]
    buffer_load_dwordx4 v[52:55], v1, s[4:7], s26 offen offset:1024
    ds_read_b128 v[144:147], v7 offset:8192
    ds_read_b128 v[148:151], v7 offset:9216
    ds_read_b128 v[152:155], v7 offset:10240
    ds_read_b128 v[156:159], v7 offset:11264
    s_waitcnt vmcnt(17) lgkmcnt(4)
    v_mfma_f32_16x16x32_bf16 v[80:83], v[56:59], v[128:131], v[80:83]
    v_mfma_f32_16x16x32_bf16 v[84:87], v[56:59], v[132:135], v[84:87]
    v_mfma_f32_16x16x32_bf16 v[88:91], v[56:59], v[136:139], v[88:91]
    v_mfma_f32_16x16x32_bf16 v[92:95], v[56:59], v[140:143], v[92:95]
    buffer_load_dwordx4 v[56:59], v1, s[4:7], s26 offen offset:2048
    s_waitcnt vmcnt(17)
    v_mfma_f32_16x16x32_bf16 v[96:99], v[60:63], v[128:131], v[96:99]
    v_mfma_f32_16x16x32_bf16 v[100:103], v[60:63], v[132:135], v[100:103]
    v_mfma_f32_16x16x32_bf16 v[104:107], v[60:63], v[136:139], v[104:107]
    v_mfma_f32_16x16x32_bf16 v[108:111], v[60:63], v[140:143], v[108:111]
    buffer_load_dwordx4 v[60:63], v1, s[4:7], s26 offen offset:3072
    s_add_u32 s26, s26, 4096
    s_waitcnt vmcnt(17)
    v_mfma_f32_16x16x32_bf16 v[112:115], v[64:67], v[128:131], v[112:115]
    v_mfma_f32_16x16x32_bf16 v[116:119], v[64:67], v[132:135], v[116:119]
    v_mfma_f32_16x16x32_bf16 v[120:123], v[64:67], v[136:139], v[120:123]
    v_mfma_f32_16x16x32_bf16 v[124:127], v[64:67], v[140:143], v[124:127]
    buffer_load_dwordx4 v[64:67], v1, s[4:7], s26 offen
    s_mov_b32 s29, 0x400000
Lh28:
    ds_read_b32 v3, v2 offset:64
    s_waitcnt lgkmcnt(0)
    v_cmp_gt_u32 vcc, s28, v3
    s_nop 1
    s_cbranch_vccz Lhd29
    s_sub_u32 s29, s29, 1
    s_cbranch_scc0 Lh28
Lhd29:
    ds_read_b128 v[128:131], v7 offset:12288
    ds_read_b128 v[132:135], v7 offset:13312
    ds_read_b128 v[136:139], v7 offset:14336
    ds_read_b128 v[140:143], v7 offset:15360
    s_waitcnt vmcnt(17) lgkmcnt(4)
    v_mfma_f32_16x16x32_bf16 v[80:83], v[68:71], v[144:147], v[80:83]
    v_mfma_f32_16x16x32_bf16 v[84:87], v[68:71], v[148:151], v[84:87]
    v_mfma_f32_16x16x32_bf16 v[88:91], v[68:71], v[152:155], v[88:91]
    v_mfma_f32_16x16x32_bf16 v[92:95], v[68:71], v[156:159], v[92:95]
    buffer_load_dwordx4 v[68:71], v1, s[4:7], s26 offen offset:1024
    s_waitcnt vmcnt(17)
    v_mfma_f32_16x16x32_bf16 v[96:99], v[72:75], v[144:147], v[96:99]
    v_mfma_f32_16x16x32_bf16 v[100:103], v[72:75], v[148:151], v[100:103]
    v_mfma_f32_16x16x32_bf16 v[104:107], v[72:75], v[152:155], v[104:107]
    v_mfma_f32_16x16x32_bf16 v[108:111], v[72:75], v[156:159], v[108:111]
    buffer_load_dwordx4 v[72:75], v1, s[4:7], s26 offen offset:2048
    s_waitcnt vmcnt(17)
    v_mfma_f32_16x16x32_bf16 v[112:115], v[76:79], v[144:147], v[112:115]
    v_mfma_f32_16x16x32_bf16 v[116:119], v[76:79], v[148:151], v[116:119]
    v_mfma_f32_16x16x32_bf16 v[120:123], v[76:79], v[152:155], v[120:123]
    v_mfma_f32_16x16x32_bf16 v[124:127], v[76:79], v[156:159], v[124:127]
    buffer_load_dwordx4 v[76:79], v1, s[4:7], s26 offen offset:3072
    s_add_u32 s26, s26, 4096
    ds_read_b128 v[144:147], v7 offset:16384
    ds_read_b128 v[148:151], v7 offset:17408
    ds_read_b128 v[152:155], v7 offset:18432
    ds_read_b128 v[156:159], v7 offset:19456
    s_waitcnt vmcnt(17) lgkmcnt(4)
    v_mfma_f32_16x16x32_bf16 v[80:83], v[8:11], v[128:131], v[80:83]
    v_mfma_f32_16x16x32_bf16 v[84:87], v[8:11], v[132:135], v[84:87]
    v_mfma_f32_16x16x32_bf16 v[88:91], v[8:11], v[136:139], v[88:91]
    v_mfma_f32_16x16x32_bf16 v[92:95], v[8:11], v[140:143], v[92:95]
    s_waitcnt vmcnt(16)
    v_mfma_f32_16x16x32_bf16 v[96:99], v[12:15], v[128:131], v[96:99]
    v_mfma_f32_16x16x32_bf16 v[100:103], v[12:15], v[132:135], v[100:103]
    v_mfma_f32_16x16x32_bf16 v[104:107], v[12:15], v[136:139], v[104:107]
    v_mfma_f32_16x16x32_bf16 v[108:111], v[12:15], v[140:143], v[108:111]
    s_waitcnt vmcnt(15)
    v_mfma_f32_16x16x32_bf16 v[112:115], v[16:19], v[128:131], v[112:115]
    v_mfma_f32_16x16x32_bf16 v[116:119], v[16:19], v[132:135], v[116:119]
    v_mfma_f32_16x16x32_bf16 v[120:123], v[16:19], v[136:139], v[120:123]
    v_mfma_f32_16x16x32_bf16 v[124:127], v[16:19], v[140:143], v[124:127]
    ds_read_b128 v[128:131], v7 offset:20480
    ds_read_b128 v[132:135], v7 offset:21504
    ds_read_b128 v[136:139], v7 offset:22528
    ds_read_b128 v[140:143], v7 offset:23552
    s_waitcnt vmcnt(14) lgkmcnt(4)
    v_mfma_f32_16x16x32_bf16 v[80:83], v[20:23], v[144:147], v[80:83]
    v_mfma_f32_16x16x32_bf16 v[84:87], v[20:23], v[148:151], v[84:87]
    v_mfma_f32_16x16x32_bf16 v[88:91], v[20:23], v[152:155], v[88:91]
    v_mfma_f32_16x16x32_bf16 v[92:95], v[20:23], v[156:159], v[92:95]
    s_waitcnt vmcnt(13)
    v_mfma_f32_16x16x32_bf16 v[96:99], v[24:27], v[144:147], v[96:99]
    v_mfma_f32_16x16x32_bf16 v[100:103], v[24:27], v[148:151], v[100:103]
    v_mfma_f32_16x16x32_bf16 v[104:107], v[24:27], v[152:155], v[104:107]
    v_mfma_f32_16x16x32_bf16 v[108:111], v[24:27], v[156:159], v[108:111]
    s_waitcnt vmcnt(12)
    v_mfma_f32_16x16x32_bf16 v[112:115], v[28:31], v[144:147], v[112:115]
    v_mfma_f32_16x16x32_bf16 v[116:119], v[28:31], v[148:151], v[116:119]
    v_mfma_f32_16x16x32_bf16 v[120:123], v[28:31], v[152:155], v[120:123]
    v_mfma_f32_16x16x32_bf16 v[124:127], v[28:31], v[156:159], v[124:127]
    ds_read_b128 v[144:147], v7 offset:24576
    ds_read_b128 v[148:151], v7 offset:25600
    ds_read_b128 v[152:155], v7 offset:26624
    ds_read_b128 v[156:159], v7 offset:27648
    s_waitcnt vmcnt(11) lgkmcnt(4)
    v_mfma_f32_16x16x32_bf16 v[80:83], v[32:35], v[128:131], v[80:83]
    v_mfma_f32_16x16x32_bf16 v[84:87], v[32:35], v[132:135], v[84:87]
    v_mfma_f32_16x16x32_bf16 v[88:91], v[32:35], v[136:139], v[88:91]
    v_mfma_f32_16x16x32_bf16 v[92:95], v[32:35], v[140:143], v[92:95]
    s_waitcnt vmcnt(10)
    v_mfma_f32_16x16x32_bf16 v[96:99], v[36:39], v[128:131], v[96:99]
    v_mfma_f32_16x16x32_bf16 v[100:103], v[36:39], v[132:135], v[100:103]
    v_mfma_f32_16x16x32_bf16 v[104:107], v[36:39], v[136:139], v[104:107]
    v_mfma_f32_16x16x32_bf16 v[108:111], v[36:39], v[140:143], v[108:111]
    s_waitcnt vmcnt(9)
    v_mfma_f32_16x16x32_bf16 v[112:115], v[40:43], v[128:131], v[112:115]
    v_mfma_f32_16x16x32_bf16 v[116:119], v[40:43], v[132:135], v[116:119]
    v_mfma_f32_16x16x32_bf16 v[120:123], v[40:43], v[136:139], v[120:123]
    v_mfma_f32_16x16x32_bf16 v[124:127], v[40:43], v[140:143], v[124:127]
    ds_read_b128 v[128:131], v7 offset:28672
    ds_read_b128 v[132:135], v7 offset:29696
    ds_read_b128 v[136:139], v7 offset:30720
    ds_read_b128 v[140:143], v7 offset:31744
    s_waitcnt vmcnt(8) lgkmcnt(4)
    v_mfma_f32_16x16x32_bf16 v[80:83], v[44:47], v[144:147], v[80:83]
    v_mfma_f32_16x16x32_bf16 v[84:87], v[44:47], v[148:151], v[84:87]
    v_mfma_f32_16x16x32_bf16 v[88:91], v[44:47], v[152:155], v[88:91]
    v_mfma_f32_16x16x32_bf16 v[92:95], v[44:47], v[156:159], v[92:95]
    s_waitcnt vmcnt(7)
    v_mfma_f32_16x16x32_bf16 v[96:99], v[48:51], v[144:147], v[96:99]
    v_mfma_f32_16x16x32_bf16 v[100:103], v[48:51], v[148:151], v[100:103]
    v_mfma_f32_16x16x32_bf16 v[104:107], v[48:51], v[152:155], v[104:107]
    v_mfma_f32_16x16x32_bf16 v[108:111], v[48:51], v[156:159], v[108:111]
    s_waitcnt vmcnt(6)
    v_mfma_f32_16x16x32_bf16 v[112:115], v[52:55], v[144:147], v[112:115]
    v_mfma_f32_16x16x32_bf16 v[116:119], v[52:55], v[148:151], v[116:119]
    v_mfma_f32_16x16x32_bf16 v[120:123], v[52:55], v[152:155], v[120:123]
    v_mfma_f32_16x16x32_bf16 v[124:127], v[52:55], v[156:159], v[124:127]
    ds_read_b128 v[144:147], v7 offset:32768
    ds_read_b128 v[148:151], v7 offset:33792
    ds_read_b128 v[152:155], v7 offset:34816
    ds_read_b128 v[156:159], v7 offset:35840
    s_waitcnt vmcnt(5) lgkmcnt(4)
    v_mfma_f32_16x16x32_bf16 v[80:83], v[56:59], v[128:131], v[80:83]
    v_mfma_f32_16x16x32_bf16 v[84:87], v[56:59], v[132:135], v[84:87]
    v_mfma_f32_16x16x32_bf16 v[88:91], v[56:59], v[136:139], v[88:91]
    v_mfma_f32_16x16x32_bf16 v[92:95], v[56:59], v[140:143], v[92:95]
    s_waitcnt vmcnt(4)
    v_mfma_f32_16x16x32_bf16 v[96:99], v[60:63], v[128:131], v[96:99]
    v_mfma_f32_16x16x32_bf16 v[100:103], v[60:63], v[132:135], v[100:103]
    v_mfma_f32_16x16x32_bf16 v[104:107], v[60:63], v[136:139], v[104:107]
    v_mfma_f32_16x16x32_bf16 v[108:111], v[60:63], v[140:143], v[108:111]
    s_waitcnt vmcnt(3)
    v_mfma_f32_16x16x32_bf16 v[112:115], v[64:67], v[128:131], v[112:115]
    v_mfma_f32_16x16x32_bf16 v[116:119], v[64:67], v[132:135], v[116:119]
    v_mfma_f32_16x16x32_bf16 v[120:123], v[64:67], v[136:139], v[120:123]
    v_mfma_f32_16x16x32_bf16 v[124:127], v[64:67], v[140:143], v[124:127]
    s_waitcnt vmcnt(2) lgkmcnt(0)
    v_mfma_f32_16x16x32_bf16 v[80:83], v[68:71], v[144:147], v[80:83]
    v_mfma_f32_16x16x32_bf16 v[84:87], v[68:71], v[148:151], v[84:87]
    v_mfma_f32_16x16x32_bf16 v[88:91], v[68:71], v[152:155], v[88:91]
    v_mfma_f32_16x16x32_bf16 v[92:95], v[68:71], v[156:159], v[92:95]
    s_waitcnt vmcnt(1)
    v_mfma_f32_16x16x32_bf16 v[96:99], v[72:75], v[144:147], v[96:99]
    v_mfma_f32_16x16x32_bf16 v[100:103], v[72:75], v[148:151], v[100:103]
    v_mfma_f32_16x16x32_bf16 v[104:107], v[72:75], v[152:155], v[104:107]
    v_mfma_f32_16x16x32_bf16 v[108:111], v[72:75], v[156:159], v[108:111]
    s_waitcnt vmcnt(0)
    v_mfma_f32_16x16x32_bf16 v[112:115], v[76:79], v[144:147], v[112:115]
    v_mfma_f32_16x16x32_bf16 v[116:119], v[76:79], v[148:151], v[116:119]
    v_mfma_f32_16x16x32_bf16 v[120:123], v[76:79], v[152:155], v[120:123]
    v_mfma_f32_16x16x32_bf16 v[124:127], v[76:79], v[156:159], v[124:127]
C_T2:
    v_and_b32 v5, 31, v0
    v_lshlrev_b32 v5, 4, v5
    v_lshrrev_b32 v6, 5, v0
    s_mov_b32 s28, 73728
    v_mad_u32_u24 v2, v6, s28, v5
    s_and_b32 s27, s22, 3
    s_mul_i32 s27, s27, 147456
    s_lshr_b32 s28, s22, 2
    s_mul_i32 s28, s28, 3072
    s_add_u32 s28, s28, s27
    s_mul_i32 s29, s20, 589824
    s_mul_i32 s27, s23, 18874368
    s_add_u32 s29, s29, s27
    s_add_u32 s36, s29, 35700736
    s_mul_i32 s27, s21, 9216
    s_add_u32 s29, s36, s27
    s_add_u32 s29, s29, s28
    s_and_b32 s27, s22, 3
    s_lshr_b32 s28, s21, 1
    s_cmp_lg_u32 s27, s28
    s_cbranch_scc1 C_ST
    s_lshr_b32 s28, s22, 2
    s_mul_i32 s28, s28, 3072
    s_add_u32 s28, s28, 0
    v_add_u32 v7, s28, v5
    s_and_b32 s27, s21, 1
    s_sub_u32 s30, s27, 1
    s_not_b32 s31, s30
    v_cvt_pk_bf16_f32 v128, v80, v81
    v_cvt_pk_bf16_f32 v130, v84, v85
    v_cvt_pk_bf16_f32 v129, v82, v83
    v_cvt_pk_bf16_f32 v131, v86, v87
    v_permlane16_swap_b32 v128, v130
    s_nop 0
    v_permlane16_swap_b32 v129, v131
    s_not_b64 exec, s[30:31]
    buffer_store_dwordx4 v[128:131], v2, s[4:7], s29 offen offset:0 sc1
    s_mov_b64 exec, s[30:31]
    ds_write_b128 v7, v[128:131] offset:0
    s_mov_b64 exec, -1
    v_cvt_pk_bf16_f32 v132, v88, v89
    v_cvt_pk_bf16_f32 v134, v92, v93
    v_cvt_pk_bf16_f32 v133, v90, v91
    v_cvt_pk_bf16_f32 v135, v94, v95
    v_permlane16_swap_b32 v132, v134
    s_nop 0
    v_permlane16_swap_b32 v133, v135
    s_not_b64 exec, s[30:31]
    buffer_store_dwordx4 v[132:135], v2, s[4:7], s29 offen offset:512 sc1
    s_mov_b64 exec, s[30:31]
    ds_write_b128 v7, v[132:135] offset:512
    s_mov_b64 exec, -1
    v_cvt_pk_bf16_f32 v136, v96, v97
    v_cvt_pk_bf16_f32 v138, v100, v101
    v_cvt_pk_bf16_f32 v137, v98, v99
    v_cvt_pk_bf16_f32 v139, v102, v103
    v_permlane16_swap_b32 v136, v138
    s_nop 0
    v_permlane16_swap_b32 v137, v139
    s_not_b64 exec, s[30:31]
    buffer_store_dwordx4 v[136:139], v2, s[4:7], s29 offen offset:1024 sc1
    s_mov_b64 exec, s[30:31]
    ds_write_b128 v7, v[136:139] offset:1024
    s_mov_b64 exec, -1
    v_cvt_pk_bf16_f32 v140, v104, v105
    v_cvt_pk_bf16_f32 v142, v108, v109
    v_cvt_pk_bf16_f32 v141, v106, v107
    v_cvt_pk_bf16_f32 v143, v110, v111
    v_permlane16_swap_b32 v140, v142
    s_nop 0
    v_permlane16_swap_b32 v141, v143
    s_not_b64 exec, s[30:31]
    buffer_store_dwordx4 v[140:143], v2, s[4:7], s29 offen offset:1536 sc1
    s_mov_b64 exec, s[30:31]
    ds_write_b128 v7, v[140:143] offset:1536
    s_mov_b64 exec, -1
    v_cvt_pk_bf16_f32 v144, v112, v113
    v_cvt_pk_bf16_f32 v146, v116, v117
    v_cvt_pk_bf16_f32 v145, v114, v115
    v_cvt_pk_bf16_f32 v147, v118, v119
    v_permlane16_swap_b32 v144, v146
    s_nop 0
    v_permlane16_swap_b32 v145, v147
    s_not_b64 exec, s[30:31]
    buffer_store_dwordx4 v[144:147], v2, s[4:7], s29 offen offset:2048 sc1
    s_mov_b64 exec, s[30:31]
    ds_write_b128 v7, v[144:147] offset:2048
    s_mov_b64 exec, -1
    v_cvt_pk_bf16_f32 v148, v120, v121
    v_cvt_pk_bf16_f32 v150, v124, v125
    v_cvt_pk_bf16_f32 v149, v122, v123
    v_cvt_pk_bf16_f32 v151, v126, v127
    v_permlane16_swap_b32 v148, v150
    s_nop 0
    v_permlane16_swap_b32 v149, v151
    s_not_b64 exec, s[30:31]
    buffer_store_dwordx4 v[148:151], v2, s[4:7], s29 offen offset:2560 sc1
    s_mov_b64 exec, s[30:31]
    ds_write_b128 v7, v[148:151] offset:2560
    s_mov_b64 exec, -1
    s_branch C_ST2
C_ST:
    v_cvt_pk_bf16_f32 v128, v80, v81
    v_cvt_pk_bf16_f32 v130, v84, v85
    v_cvt_pk_bf16_f32 v129, v82, v83
    v_cvt_pk_bf16_f32 v131, v86, v87
    v_permlane16_swap_b32 v128, v130
    s_nop 0
    v_permlane16_swap_b32 v129, v131
    buffer_store_dwordx4 v[128:131], v2, s[4:7], s29 offen offset:0 sc1
    v_cvt_pk_bf16_f32 v132, v88, v89
    v_cvt_pk_bf16_f32 v134, v92, v93
    v_cvt_pk_bf16_f32 v133, v90, v91
    v_cvt_pk_bf16_f32 v135, v94, v95
    v_permlane16_swap_b32 v132, v134
    s_nop 0
    v_permlane16_swap_b32 v133, v135
    buffer_store_dwordx4 v[132:135], v2, s[4:7], s29 offen offset:512 sc1
    v_cvt_pk_bf16_f32 v136, v96, v97
    v_cvt_pk_bf16_f32 v138, v100, v101
    v_cvt_pk_bf16_f32 v137, v98, v99
    v_cvt_pk_bf16_f32 v139, v102, v103
    v_permlane16_swap_b32 v136, v138
    s_nop 0
    v_permlane16_swap_b32 v137, v139
    buffer_store_dwordx4 v[136:139], v2, s[4:7], s29 offen offset:1024 sc1
    v_cvt_pk_bf16_f32 v140, v104, v105
    v_cvt_pk_bf16_f32 v142, v108, v109
    v_cvt_pk_bf16_f32 v141, v106, v107
    v_cvt_pk_bf16_f32 v143, v110, v111
    v_permlane16_swap_b32 v140, v142
    s_nop 0
    v_permlane16_swap_b32 v141, v143
    buffer_store_dwordx4 v[140:143], v2, s[4:7], s29 offen offset:1536 sc1
    v_cvt_pk_bf16_f32 v144, v112, v113
    v_cvt_pk_bf16_f32 v146, v116, v117
    v_cvt_pk_bf16_f32 v145, v114, v115
    v_cvt_pk_bf16_f32 v147, v118, v119
    v_permlane16_swap_b32 v144, v146
    s_nop 0
    v_permlane16_swap_b32 v145, v147
    buffer_store_dwordx4 v[144:147], v2, s[4:7], s29 offen offset:2048 sc1
    v_cvt_pk_bf16_f32 v148, v120, v121
    v_cvt_pk_bf16_f32 v150, v124, v125
    v_cvt_pk_bf16_f32 v149, v122, v123
    v_cvt_pk_bf16_f32 v151, v126, v127
    v_permlane16_swap_b32 v148, v150
    s_nop 0
    v_permlane16_swap_b32 v149, v151
    buffer_store_dwordx4 v[148:151], v2, s[4:7], s29 offen offset:2560 sc1
C_ST2:
    s_setprio 0
    s_lshl_b32 s27, s63, 10
    s_add_u32 s28, s27, 147456
    v_add_u32 v5, s28, v1
    ds_read_b128 v[88:91], v5
    s_add_u32 s36, s36, s27
    s_mul_i32 s27, s21, 73728
    s_add_u32 s36, s36, s27
    s_mov_b32 s37, 0xffff0000
    s_lshl_b32 s38, s20, 9
    s_add_u32 s38, s38, 8192
    s_lshl_b32 s27, s22, 5
    s_lshl_b32 s28, s21, 2
    s_add_u32 s27, s27, s28
    s_add_u32 s27, s27, s38
    s_add_u32 s39, s23, 1
    v_mov_b32 v3, s39
    v_mov_b32 v4, 0
    s_waitcnt lgkmcnt(0)
    v_lshlrev_b32 v80, 16, v88
    v_and_b32 v81, s37, v88
    v_add_f32 v80, s48, v80
    v_add_f32 v81, s49, v81
    v_lshlrev_b32 v82, 16, v89
    v_and_b32 v83, s37, v89
    v_add_f32 v82, s50, v82
    v_add_f32 v83, s51, v83
    v_lshlrev_b32 v84, 16, v90
    v_and_b32 v85, s37, v90
    v_add_f32 v84, s52, v84
    v_add_f32 v85, s53, v85
    v_lshlrev_b32 v86, 16, v91
    v_and_b32 v87, s37, v91
    v_add_f32 v86, s54, v86
    v_add_f32 v87, s55, v87
    s_waitcnt vmcnt(0)
    s_mov_b64 exec, 1
    buffer_store_dword v3, v4, s[4:7], s27 offen sc1
    s_mov_b64 exec, -1
    s_barrier
    s_and_b32 s27, s22, 3
    s_cmp_eq_u32 s27, 3
    s_cbranch_scc1 D_IDLE
    s_and_b32 s27, s22, 12
    s_lshr_b32 s28, s21, 1
    s_add_u32 s27, s27, s28
    s_lshl_b32 s27, s27, 5
    s_add_u32 s28, s27, s38
    v_lshlrev_b32 v2, 2, v0
    s_mov_b64 exec, 0xff
    s_bitset0_b32 exec_lo, s21
    s_cmp_lg_u32 s25, 0
    s_cbranch_scc1 Lsd31
    s_mov_b32 s29, 400000
Lsl30:
    buffer_load_dword v3, v2, s[4:7], s28 offen sc1
    s_waitcnt vmcnt(0)
    v_cmp_gt_u32 vcc, s39, v3
    s_nop 1
    s_cbranch_vccz Lsd31
    s_sub_u32 s29, s29, 1
    s_cbranch_scc0 Lsl30
    s_mov_b32 s25, 1
Lsd31:
    s_mov_b64 exec, -1
    s_lshl_b32 s27, s63, 10
    s_add_u32 s27, s27, 0
    v_add_u32 v2, s27, v1
    ds_read_b128 v[128:131], v2
    s_add_u32 s27, s21, 1
    s_and_b32 s27, s27, 7
    s_mul_i32 s27, s27, 9216
    s_add_u32 s27, s27, s36
    buffer_load_dwordx4 v[132:135], v1, s[4:7], s27 offen sc1
    s_add_u32 s27, s21, 2
    s_and_b32 s27, s27, 7
    s_mul_i32 s27, s27, 9216
    s_add_u32 s27, s27, s36
    buffer_load_dwordx4 v[136:139], v1, s[4:7], s27 offen sc1
    s_add_u32 s27, s21, 3
    s_and_b32 s27, s27, 7
    s_mul_i32 s27, s27, 9216
    s_add_u32 s27, s27, s36
    buffer_load_dwordx4 v[140:143], v1, s[4:7], s27 offen sc1
    s_add_u32 s27, s21, 4
    s_and_b32 s27, s27, 7
    s_mul_i32 s27, s27, 9216
    s_add_u32 s27, s27, s36
    buffer_load_dwordx4 v[144:147], v1, s[4:7], s27 offen sc1
    s_add_u32 s27, s21, 5
    s_and_b32 s27, s27, 7
    s_mul_i32 s27, s27, 9216
    s_add_u32 s27, s27, s36
    buffer_load_dwordx4 v[148:151], v1, s[4:7], s27 offen sc1
    s_add_u32 s27, s21, 6
    s_and_b32 s27, s27, 7
    s_mul_i32 s27, s27, 9216
    s_add_u32 s27, s27, s36
    buffer_load_dwordx4 v[152:155], v1, s[4:7], s27 offen sc1
    s_add_u32 s27, s21, 7
    s_and_b32 s27, s27, 7
    s_mul_i32 s27, s27, 9216
    s_add_u32 s27, s27, s36
    buffer_load_dwordx4 v[156:159], v1, s[4:7], s27 offen sc1
    s_waitcnt lgkmcnt(0)
    s_mul_i32 s27, s21, 9
    s_add_u32 s27, s27, s63
    s_lshr_b32 s28, s27, 2
    s_lshl_b32 s28, s28, 12
    s_and_b32 s27, s27, 3
    s_lshl_b32 s27, s27, 8
    s_add_u32 s28, s28, s27
    v_lshrrev_b32 v2, 4, v0
    v_lshlrev_b32 v2, 10, v2
    v_and_b32 v3, 15, v0
    v_lshl_add_u32 v2, v3, 4, v2
    v_add_u32 v2, s28, v2
    s_mul_i32 s29, s20, 73728
    s_add_u32 s29, s29, 33341440
    s_mov_b32 s61, 0xc0088e99
    s_lshl_b32 s36, s20, 6
    v_add_u32 v3, s36, v0
    v_mul_u32_u24 v3, 1152, v3
    v_lshlrev_b32 v92, 16, v128
    v_and_b32 v93, s37, v128
    v_lshlrev_b32 v94, 16, v129
    v_and_b32 v95, s37, v129
    v_lshlrev_b32 v96, 16, v130
    v_and_b32 v97, s37, v130
    v_lshlrev_b32 v98, 16, v131
    v_and_b32 v99, s37, v131
    v_pk_fma_f32 v[80:81], v[92:93], s[60:61], v[80:81] op_sel:[0,1,0] op_sel_hi:[1,1,1]
    v_pk_fma_f32 v[82:83], v[94:95], s[60:61], v[82:83] op_sel:[0,1,0] op_sel_hi:[1,1,1]
    v_pk_fma_f32 v[84:85], v[96:97], s[60:61], v[84:85] op_sel:[0,1,0] op_sel_hi:[1,1,1]
    v_pk_fma_f32 v[86:87], v[98:99], s[60:61], v[86:87] op_sel:[0,1,0] op_sel_hi:[1,1,1]
    s_waitcnt vmcnt(6)
    v_lshlrev_b32 v92, 16, v132
    v_and_b32 v93, s37, v132
    v_lshlrev_b32 v94, 16, v133
    v_and_b32 v95, s37, v133
    v_lshlrev_b32 v96, 16, v134
    v_and_b32 v97, s37, v134
    v_lshlrev_b32 v98, 16, v135
    v_and_b32 v99, s37, v135
    v_pk_fma_f32 v[80:81], v[92:93], s[60:61], v[80:81] op_sel:[0,1,0] op_sel_hi:[1,1,1]
    v_pk_fma_f32 v[82:83], v[94:95], s[60:61], v[82:83] op_sel:[0,1,0] op_sel_hi:[1,1,1]
    v_pk_fma_f32 v[84:85], v[96:97], s[60:61], v[84:85] op_sel:[0,1,0] op_sel_hi:[1,1,1]
    v_pk_fma_f32 v[86:87], v[98:99], s[60:61], v[86:87] op_sel:[0,1,0] op_sel_hi:[1,1,1]
    s_waitcnt vmcnt(5)
    v_lshlrev_b32 v92, 16, v136
    v_and_b32 v93, s37, v136
    v_lshlrev_b32 v94, 16, v137
    v_and_b32 v95, s37, v137
    v_lshlrev_b32 v96, 16, v138
    v_and_b32 v97, s37, v138
    v_lshlrev_b32 v98, 16, v139
    v_and_b32 v99, s37, v139
    v_pk_fma_f32 v[80:81], v[92:93], s[60:61], v[80:81] op_sel:[0,1,0] op_sel_hi:[1,1,1]
    v_pk_fma_f32 v[82:83], v[94:95], s[60:61], v[82:83] op_sel:[0,1,0] op_sel_hi:[1,1,1]
    v_pk_fma_f32 v[84:85], v[96:97], s[60:61], v[84:85] op_sel:[0,1,0] op_sel_hi:[1,1,1]
    v_pk_fma_f32 v[86:87], v[98:99], s[60:61], v[86:87] op_sel:[0,1,0] op_sel_hi:[1,1,1]
    s_waitcnt vmcnt(4)
    v_lshlrev_b32 v92, 16, v140
    v_and_b32 v93, s37, v140
    v_lshlrev_b32 v94, 16, v141
    v_and_b32 v95, s37, v141
    v_lshlrev_b32 v96, 16, v142
    v_and_b32 v97, s37, v142
    v_lshlrev_b32 v98, 16, v143
    v_and_b32 v99, s37, v143
    v_pk_fma_f32 v[80:81], v[92:93], s[60:61], v[80:81] op_sel:[0,1,0] op_sel_hi:[1,1,1]
    v_pk_fma_f32 v[82:83], v[94:95], s[60:61], v[82:83] op_sel:[0,1,0] op_sel_hi:[1,1,1]
    v_pk_fma_f32 v[84:85], v[96:97], s[60:61], v[84:85] op_sel:[0,1,0] op_sel_hi:[1,1,1]
    v_pk_fma_f32 v[86:87], v[98:99], s[60:61], v[86:87] op_sel:[0,1,0] op_sel_hi:[1,1,1]
    s_waitcnt vmcnt(3)
    v_lshlrev_b32 v92, 16, v144
    v_and_b32 v93, s37, v144
    v_lshlrev_b32 v94, 16, v145
    v_and_b32 v95, s37, v145
    v_lshlrev_b32 v96, 16, v146
    v_and_b32 v97, s37, v146
    v_lshlrev_b32 v98, 16, v147
    v_and_b32 v99, s37, v147
    v_pk_fma_f32 v[80:81], v[92:93], s[60:61], v[80:81] op_sel:[0,1,0] op_sel_hi:[1,1,1]
    v_pk_fma_f32 v[82:83], v[94:95], s[60:61], v[82:83] op_sel:[0,1,0] op_sel_hi:[1,1,1]
    v_pk_fma_f32 v[84:85], v[96:97], s[60:61], v[84:85] op_sel:[0,1,0] op_sel_hi:[1,1,1]
    v_pk_fma_f32 v[86:87], v[98:99], s[60:61], v[86:87] op_sel:[0,1,0] op_sel_hi:[1,1,1]
    s_waitcnt vmcnt(2)
    v_lshlrev_b32 v92, 16, v148
    v_and_b32 v93, s37, v148
    v_lshlrev_b32 v94, 16, v149
    v_and_b32 v95, s37, v149
    v_lshlrev_b32 v96, 16, v150
    v_and_b32 v97, s37, v150
    v_lshlrev_b32 v98, 16, v151
    v_and_b32 v99, s37, v151
    v_pk_fma_f32 v[80:81], v[92:93], s[60:61], v[80:81] op_sel:[0,1,0] op_sel_hi:[1,1,1]
    v_pk_fma_f32 v[82:83], v[94:95], s[60:61], v[82:83] op_sel:[0,1,0] op_sel_hi:[1,1,1]
    v_pk_fma_f32 v[84:85], v[96:97], s[60:61], v[84:85] op_sel:[0,1,0] op_sel_hi:[1,1,1]
    v_pk_fma_f32 v[86:87], v[98:99], s[60:61], v[86:87] op_sel:[0,1,0] op_sel_hi:[1,1,1]
    s_waitcnt vmcnt(1)
    v_lshlrev_b32 v92, 16, v152
    v_and_b32 v93, s37, v152
    v_lshlrev_b32 v94, 16, v153
    v_and_b32 v95, s37, v153
    v_lshlrev_b32 v96, 16, v154
    v_and_b32 v97, s37, v154
    v_lshlrev_b32 v98, 16, v155
    v_and_b32 v99, s37, v155
    v_pk_fma_f32 v[80:81], v[92:93], s[60:61], v[80:81] op_sel:[0,1,0] op_sel_hi:[1,1,1]
    v_pk_fma_f32 v[82:83], v[94:95], s[60:61], v[82:83] op_sel:[0,1,0] op_sel_hi:[1,1,1]
    v_pk_fma_f32 v[84:85], v[96:97], s[60:61], v[84:85] op_sel:[0,1,0] op_sel_hi:[1,1,1]
    v_pk_fma_f32 v[86:87], v[98:99], s[60:61], v[86:87] op_sel:[0,1,0] op_sel_hi:[1,1,1]
    s_waitcnt vmcnt(0)
    v_lshlrev_b32 v92, 16, v156
    v_and_b32 v93, s37, v156
    v_lshlrev_b32 v94, 16, v157
    v_and_b32 v95, s37, v157
    v_lshlrev_b32 v96, 16, v158
    v_and_b32 v97, s37, v158
    v_lshlrev_b32 v98, 16, v159
    v_and_b32 v99, s37, v159
    v_pk_fma_f32 v[80:81], v[92:93], s[60:61], v[80:81] op_sel:[0,1,0] op_sel_hi:[1,1,1]
    v_pk_fma_f32 v[82:83], v[94:95], s[60:61], v[82:83] op_sel:[0,1,0] op_sel_hi:[1,1,1]
    v_pk_fma_f32 v[84:85], v[96:97], s[60:61], v[84:85] op_sel:[0,1,0] op_sel_hi:[1,1,1]
    v_pk_fma_f32 v[86:87], v[98:99], s[60:61], v[86:87] op_sel:[0,1,0] op_sel_hi:[1,1,1]
    v_cvt_pk_bf16_f32 v88, v80, v81
    v_cvt_pk_bf16_f32 v89, v82, v83
    v_cvt_pk_bf16_f32 v90, v84, v85
    v_cvt_pk_bf16_f32 v91, v86, v87
    s_cmp_eq_u32 s23, 0
    s_cbranch_scc1 D_MID
    buffer_store_dwordx4 v[88:91], v3, s[12:15], s43 offen
    s_branch D_DONE
D_IDLE:
    s_branch D_DONE
    s_cmp_lg_u32 s23, 0
    s_cbranch_scc1 D_DONE
    s_cmp_lt_u32 s22, 0
    s_cbranch_scc1 D_DONE
    s_mov_b32 s26, s40
    buffer_load_dwordx4 v[8:11], v1, s[4:7], s26 offen
    buffer_load_dwordx4 v[12:15], v1, s[4:7], s26 offen offset:1024
    buffer_load_dwordx4 v[16:19], v1, s[4:7], s26 offen offset:2048
    buffer_load_dwordx4 v[20:23], v1, s[4:7], s26 offen offset:3072
    s_add_u32 s26, s26, 4096
    buffer_load_dwordx4 v[24:27], v1, s[4:7], s26 offen
    buffer_load_dwordx4 v[28:31], v1, s[4:7], s26 offen offset:1024
    buffer_load_dwordx4 v[32:35], v1, s[4:7], s26 offen offset:2048
    buffer_load_dwordx4 v[36:39], v1, s[4:7], s26 offen offset:3072
    s_add_u32 s26, s26, 4096
    buffer_load_dwordx4 v[40:43], v1, s[4:7], s26 offen
    buffer_load_dwordx4 v[44:47], v1, s[4:7], s26 offen offset:1024
    buffer_load_dwordx4 v[48:51], v1, s[4:7], s26 offen offset:2048
    buffer_load_dwordx4 v[52:55], v1, s[4:7], s26 offen offset:3072
    s_add_u32 s26, s26, 4096
    buffer_load_dwordx4 v[56:59], v1, s[4:7], s26 offen
    buffer_load_dwordx4 v[60:63], v1, s[4:7], s26 offen offset:1024
    buffer_load_dwordx4 v[64:67], v1, s[4:7], s26 offen offset:2048
    buffer_load_dwordx4 v[68:71], v1, s[4:7], s26 offen offset:3072
    s_add_u32 s26, s26, 4096
    buffer_load_dwordx4 v[72:75], v1, s[4:7], s26 offen
    buffer_load_dwordx4 v[76:79], v1, s[4:7], s26 offen offset:1024
    s_branch D_DONE
D_MID:
    buffer_store_dwordx4 v[88:91], v2, s[4:7], s29 offen sc1
    ds_write_b128 v5, v[88:91]
    s_cmp_lt_u32 s22, 0
    s_cbranch_scc1 D_DR
    s_cmp_ge_u32 s22, 0
    s_cbranch_scc1 D_DR
    s_mov_b32 s26, s40
    buffer_load_dwordx4 v[8:11], v1, s[4:7], s26 offen
    buffer_load_dwordx4 v[12:15], v1, s[4:7], s26 offen offset:1024
    buffer_load_dwordx4 v[16:19], v1, s[4:7], s26 offen offset:2048
    buffer_load_dwordx4 v[20:23], v1, s[4:7], s26 offen offset:3072
    s_add_u32 s26, s26, 4096
    buffer_load_dwordx4 v[24:27], v1, s[4:7], s26 offen
    buffer_load_dwordx4 v[28:31], v1, s[4:7], s26 offen offset:1024
    buffer_load_dwordx4 v[32:35], v1, s[4:7], s26 offen offset:2048
    buffer_load_dwordx4 v[36:39], v1, s[4:7], s26 offen offset:3072
    s_add_u32 s26, s26, 4096
    buffer_load_dwordx4 v[40:43], v1, s[4:7], s26 offen
    buffer_load_dwordx4 v[44:47], v1, s[4:7], s26 offen offset:1024
    buffer_load_dwordx4 v[48:51], v1, s[4:7], s26 offen offset:2048
    buffer_load_dwordx4 v[52:55], v1, s[4:7], s26 offen offset:3072
    s_add_u32 s26, s26, 4096
    buffer_load_dwordx4 v[56:59], v1, s[4:7], s26 offen
    buffer_load_dwordx4 v[60:63], v1, s[4:7], s26 offen offset:1024
    buffer_load_dwordx4 v[64:67], v1, s[4:7], s26 offen offset:2048
    buffer_load_dwordx4 v[68:71], v1, s[4:7], s26 offen offset:3072
    s_add_u32 s26, s26, 4096
    buffer_load_dwordx4 v[72:75], v1, s[4:7], s26 offen
    buffer_load_dwordx4 v[76:79], v1, s[4:7], s26 offen offset:1024
    s_waitcnt vmcnt(18) lgkmcnt(0)
    s_branch D_DONE
D_DR:
    s_waitcnt vmcnt(0) lgkmcnt(0)
D_DONE:
    s_cmp_lg_u32 s23, 0
    s_cbranch_scc1 M_FIN
    s_barrier
    s_cmp_lg_u32 s22, 0
    s_cbranch_scc1 Lf32
    s_add_u32 s27, s24, 5
    s_lshl_b32 s28, s20, 8
    s_lshl_b32 s29, s21, 2
    s_add_u32 s28, s28, s29
    v_mov_b32 v2, s27
    v_mov_b32 v3, 0
    s_mov_b64 exec, 1
    buffer_store_dword v2, v3, s[4:7], s28 offen sc1
    s_mov_b64 exec, -1
Lf32:
    s_cmp_ge_u32 s22, 5
    s_cbranch_scc1 D_NP
    s_cmp_lt_u32 s22, 0
    s_cbranch_scc1 D_NP
    s_and_b32 s27, s22, 3
    s_cmp_eq_u32 s27, 4
    s_cbranch_scc1 D_NP
    s_mov_b32 s26, s40
    buffer_load_dwordx4 v[8:11], v1, s[4:7], s26 offen
    buffer_load_dwordx4 v[12:15], v1, s[4:7], s26 offen offset:1024
    buffer_load_dwordx4 v[16:19], v1, s[4:7], s26 offen offset:2048
    buffer_load_dwordx4 v[20:23], v1, s[4:7], s26 offen offset:3072
    s_add_u32 s26, s26, 4096
    buffer_load_dwordx4 v[24:27], v1, s[4:7], s26 offen
    buffer_load_dwordx4 v[28:31], v1, s[4:7], s26 offen offset:1024
    buffer_load_dwordx4 v[32:35], v1, s[4:7], s26 offen offset:2048
    buffer_load_dwordx4 v[36:39], v1, s[4:7], s26 offen offset:3072
    s_add_u32 s26, s26, 4096
    buffer_load_dwordx4 v[40:43], v1, s[4:7], s26 offen
    buffer_load_dwordx4 v[44:47], v1, s[4:7], s26 offen offset:1024
    buffer_load_dwordx4 v[48:51], v1, s[4:7], s26 offen offset:2048
    buffer_load_dwordx4 v[52:55], v1, s[4:7], s26 offen offset:3072
    s_add_u32 s26, s26, 4096
    buffer_load_dwordx4 v[56:59], v1, s[4:7], s26 offen
    buffer_load_dwordx4 v[60:63], v1, s[4:7], s26 offen offset:1024
    buffer_load_dwordx4 v[64:67], v1, s[4:7], s26 offen offset:2048
    buffer_load_dwordx4 v[68:71], v1, s[4:7], s26 offen offset:3072
    s_add_u32 s26, s26, 4096
    buffer_load_dwordx4 v[72:75], v1, s[4:7], s26 offen
    buffer_load_dwordx4 v[76:79], v1, s[4:7], s26 offen offset:1024
D_NP:
    s_mov_b32 s23, 1
    s_mov_b32 s24, 6
    s_branch A_TOP
M_FIN:
M_END:
    s_endpgm
B_PREP:
    s_cmp_lg_u32 s23, 0
    s_cbranch_scc1 B_DONE
    s_and_b32 s27, s22, 3
    s_mul_i32 s27, s27, 11520
    s_add_u32 s27, s27, 99328
    v_add_u32 v2, s27, v1
    v_lshrrev_b32 v3, 4, v0
    v_bfe_u32 v4, v0, 2, 2
    s_cmp_lt_u32 s20, 16
    s_cselect_b32 s30, 32, 16
    s_cselect_b32 s31, 16, 144
    v_bfe_u32 v5, v0, 1, 1
    v_mul_u32_u24 v5, s31, v5
    v_and_b32 v6, 1, v0
    v_lshl_add_u32 v5, v6, 3, v5
    v_mul_u32_u24 v4, 288, v4
    v_add_u32 v5, v4, v5
    v_add_u32 v5, s27, v5
    v_mul_u32_u24 v4, 2304, v3
    v_add_u32 v6, v5, v4
    v_min_u32 v4, 2, v3
    v_mad_u32_u24 v7, v4, s30, v5
    v_add_u32 v7, 9216, v7
    v_add_u32 v3, s62, v3
    v_lshrrev_b32 v5, 2, v3
    v_mul_u32_u24 v5, 3072, v5
    v_and_b32 v3, 3, v3
    v_lshl_add_u32 v5, v3, 8, v5
    v_and_b32 v3, 15, v0
    v_lshl_add_u32 v8, v3, 4, v5
    v_lshlrev_b32 v4, 10, v4
    v_lshl_add_u32 v9, v3, 4, v4
    s_add_u32 s27, s62, 4
    s_lshr_b32 s28, s27, 2
    s_mul_i32 s28, s28, 3072
    s_and_b32 s27, s27, 3
    s_lshl_b32 s27, s27, 8
    s_add_u32 s27, s27, s28
    v_add_u32 v9, s27, v9
    s_mul_i32 s27, s21, 1327104
    s_add_u32 s27, s27, 3850240
    s_cmp_lt_u32 s20, 16
    s_cselect_b32 s28, 0, 55296
    s_add_u32 s27, s27, s28
    s_cmp_lt_u32 s20, 16
    s_cselect_b32 s29, 3, 1
    s_cselect_b32 s31, 1, 4
    s_and_b32 s28, s20, 3
    s_mul_i32 s28, s28, s29
    s_mul_i32 s28, s28, 110592
    s_mul_i32 s31, s31, 110592
    s_add_u32 s27, s27, s28
    s_add_u32 s28, s27, s31
    s_add_u32 s29, s28, s31
    s_mul_i32 s31, s30, 3
    s_waitcnt vmcnt(11)
    ds_write_b128 v2, v[16:19] offset:0
    s_waitcnt vmcnt(10)
    ds_write_b128 v2, v[20:23] offset:1024
    s_waitcnt vmcnt(9)
    ds_write_b128 v2, v[24:27] offset:2048
    s_waitcnt vmcnt(8)
    ds_write_b128 v2, v[28:31] offset:3072
    s_waitcnt vmcnt(7)
    ds_write_b128 v2, v[32:35] offset:4096
    s_waitcnt vmcnt(6)
    ds_write_b128 v2, v[36:39] offset:5120
    s_waitcnt vmcnt(5)
    ds_write_b128 v2, v[40:43] offset:6144
    s_waitcnt vmcnt(4)
    ds_write_b128 v2, v[44:47] offset:7168
    s_waitcnt vmcnt(3)
    ds_write_b128 v2, v[48:51] offset:8192
    s_waitcnt vmcnt(2)
    ds_write_b128 v2, v[52:55] offset:9216
    s_waitcnt vmcnt(1)
    ds_write_b128 v2, v[56:59] offset:10240
    s_waitcnt vmcnt(0)
    s_mov_b64 exec, 0xffff
    ds_write_b128 v2, v[60:63] offset:11264
    s_mov_b64 exec, -1
    s_waitcnt lgkmcnt(0)
    ds_read_b64_tr_b16 v[64:65], v6
    ds_read_b64_tr_b16 v[66:67], v6 offset:1152
    v_add_u32 v6, s30, v6
    ds_read_b64_tr_b16 v[68:69], v6
    ds_read_b64_tr_b16 v[70:71], v6 offset:1152
    v_add_u32 v6, s30, v6
    ds_read_b64_tr_b16 v[72:73], v6
    ds_read_b64_tr_b16 v[74:75], v6 offset:1152
    v_add_u32 v6, s30, v6
    ds_read_b64_tr_b16 v[76:77], v6
    ds_read_b64_tr_b16 v[78:79], v6 offset:1152
    v_add_u32 v6, s30, v6
    ds_read_b64_tr_b16 v[80:81], v6
    ds_read_b64_tr_b16 v[82:83], v6 offset:1152
    v_add_u32 v6, s30, v6
    ds_read_b64_tr_b16 v[84:85], v6
    ds_read_b64_tr_b16 v[86:87], v6 offset:1152
    v_add_u32 v6, s30, v6
    ds_read_b64_tr_b16 v[88:89], v6
    ds_read_b64_tr_b16 v[90:91], v6 offset:1152
    v_add_u32 v6, s30, v6
    ds_read_b64_tr_b16 v[92:93], v6
    ds_read_b64_tr_b16 v[94:95], v6 offset:1152
    v_add_u32 v6, s30, v6
    ds_read_b64_tr_b16 v[96:97], v6
    ds_read_b64_tr_b16 v[98:99], v6 offset:1152
    v_add_u32 v6, s30, v6
    ds_read_b64_tr_b16 v[100:101], v7
    ds_read_b64_tr_b16 v[102:103], v7 offset:1152
    v_add_u32 v7, s31, v7
    ds_read_b64_tr_b16 v[104:105], v7
    ds_read_b64_tr_b16 v[106:107], v7 offset:1152
    v_add_u32 v7, s31, v7
    ds_read_b64_tr_b16 v[108:109], v7
    ds_read_b64_tr_b16 v[110:111], v7 offset:1152
    v_add_u32 v7, s31, v7
    s_waitcnt lgkmcnt(15)
    buffer_store_dwordx4 v[64:67], v8, s[4:7], s27 offen offset:0 sc1
    s_waitcnt lgkmcnt(15)
    buffer_store_dwordx4 v[68:71], v8, s[4:7], s27 offen offset:1024 sc1
    s_waitcnt lgkmcnt(15)
    buffer_store_dwordx4 v[72:75], v8, s[4:7], s27 offen offset:2048 sc1
    s_waitcnt lgkmcnt(15)
    buffer_store_dwordx4 v[76:79], v8, s[4:7], s28 offen offset:0 sc1
    s_waitcnt lgkmcnt(14)
    buffer_store_dwordx4 v[80:83], v8, s[4:7], s28 offen offset:1024 sc1
    s_waitcnt lgkmcnt(12)
    buffer_store_dwordx4 v[84:87], v8, s[4:7], s28 offen offset:2048 sc1
    s_waitcnt lgkmcnt(10)
    buffer_store_dwordx4 v[88:91], v8, s[4:7], s29 offen offset:0 sc1
    s_waitcnt lgkmcnt(8)
    buffer_store_dwordx4 v[92:95], v8, s[4:7], s29 offen offset:1024 sc1
    s_waitcnt lgkmcnt(6)
    buffer_store_dwordx4 v[96:99], v8, s[4:7], s29 offen offset:2048 sc1
    s_waitcnt lgkmcnt(4)
    buffer_store_dwordx4 v[100:103], v9, s[4:7], s27 offen sc1
    s_waitcnt lgkmcnt(2)
    buffer_store_dwordx4 v[104:107], v9, s[4:7], s28 offen sc1
    s_waitcnt lgkmcnt(0)
    buffer_store_dwordx4 v[108:111], v9, s[4:7], s29 offen sc1
    s_branch B_DONE
B_FILL7:
    s_nop 15
    v_mov_b32 v48, v166
    v_mov_b32 v49, v166
    v_mov_b32 v50, v166
    v_mov_b32 v51, v166
    v_mov_b32 v52, v166
    v_mov_b32 v53, v166
    v_mov_b32 v54, v166
    v_mov_b32 v55, v166
    v_mov_b32 v56, v166
    v_mov_b32 v57, v166
    v_mov_b32 v58, v166
    v_mov_b32 v59, v166
    v_mov_b32 v60, v166
    v_mov_b32 v61, v166
    v_mov_b32 v62, v166
    v_mov_b32 v63, v166
    s_branch B_BK7
B_FILL6:
    s_nop 15
    v_mov_b32 v32, v166
    v_mov_b32 v33, v166
    v_mov_b32 v34, v166
    v_mov_b32 v35, v166
    v_mov_b32 v36, v166
    v_mov_b32 v37, v166
    v_mov_b32 v38, v166
    v_mov_b32 v39, v166
    v_mov_b32 v40, v166
    v_mov_b32 v41, v166
    v_mov_b32 v42, v166
    v_mov_b32 v43, v166
    v_mov_b32 v44, v166
    v_mov_b32 v45, v166
    v_mov_b32 v46, v166
    v_mov_b32 v47, v166
    s_branch B_BK6
B_SKIP1:
    s_nop 15
    s_branch B_GE1
B_FILL3:
    s_nop 15
    v_mov_b32 v32, v166
    v_mov_b32 v33, v166
    v_mov_b32 v34, v166
    v_mov_b32 v35, v166
    v_mov_b32 v36, v166
    v_mov_b32 v37, v166
    v_mov_b32 v38, v166
    v_mov_b32 v39, v166
    v_mov_b32 v40, v166
    v_mov_b32 v41, v166
    v_mov_b32 v42, v166
    v_mov_b32 v43, v166
    v_mov_b32 v44, v166
    v_mov_b32 v45, v166
    v_mov_b32 v46, v166
    v_mov_b32 v47, v166
    s_branch B_BK3
B_FILL4:
    s_nop 15
    v_mov_b32 v48, v166
    v_mov_b32 v49, v166
    v_mov_b32 v50, v166
    v_mov_b32 v51, v166
    v_mov_b32 v52, v166
    v_mov_b32 v53, v166
    v_mov_b32 v54, v166
    v_mov_b32 v55, v166
    v_mov_b32 v56, v166
    v_mov_b32 v57, v166
    v_mov_b32 v58, v166
    v_mov_b32 v59, v166
    v_mov_b32 v60, v166
    v_mov_b32 v61, v166
    v_mov_b32 v62, v166
    v_mov_b32 v63, v166
    s_branch B_BK4
B_SKIP0:
    s_nop 15
    s_branch B_GE0
B_FILL0:
    s_nop 15
    v_mov_b32 v32, v166
    v_mov_b32 v33, v166
    v_mov_b32 v34, v166
    v_mov_b32 v35, v166
    v_mov_b32 v36, v166
    v_mov_b32 v37, v166
    v_mov_b32 v38, v166
    v_mov_b32 v39, v166
    v_mov_b32 v40, v166
    v_mov_b32 v41, v166
    v_mov_b32 v42, v166
    v_mov_b32 v43, v166
    v_mov_b32 v44, v166
    v_mov_b32 v45, v166
    v_mov_b32 v46, v166
    v_mov_b32 v47, v166
    s_branch B_BK0
B_FILL1:
    s_nop 15
    v_mov_b32 v48, v166
    v_mov_b32 v49, v166
    v_mov_b32 v50, v166
    v_mov_b32 v51, v166
    v_mov_b32 v52, v166
    v_mov_b32 v53, v166
    v_mov_b32 v54, v166
    v_mov_b32 v55, v166
    v_mov_b32 v56, v166
    v_mov_b32 v57, v166
    v_mov_b32 v58, v166
    v_mov_b32 v59, v166
    v_mov_b32 v60, v166
    v_mov_b32 v61, v166
    v_mov_b32 v62, v166
    v_mov_b32 v63, v166
    s_branch B_BK1
.section .rodata,"a"
.p2align 6
.amdhsa_kernel main_kernel
  .amdhsa_next_free_vgpr 168
  .amdhsa_next_free_sgpr 102
  .amdhsa_accum_offset 168
  .amdhsa_group_segment_fixed_size 0
  .amdhsa_kernarg_size 88
  .amdhsa_user_sgpr_count 2
  .amdhsa_user_sgpr_kernarg_segment_ptr 1
  .amdhsa_system_sgpr_workgroup_id_x 1
.end_amdhsa_kernel
```
